```python
import torch

def _softmax(x, axis=-1):
    return torch.softmax(x, dim=axis)
def _gelu(x):
    return torch.nn.functional.gelu(x, approximate="tanh")
def _silu(x):
    return torch.nn.functional.silu(x)
def _sigmoid(x):
    return torch.sigmoid(x)
def _layernorm(x, axis=-1, eps=1e-5):
    m = x.mean(dim=axis, keepdim=True)
    v = x.var(dim=axis, keepdim=True, unbiased=False)
    return (x - m) / torch.sqrt(v + eps)
def _scatter_add(tgt, idx, src, axis=0):
    return tgt.clone().index_add_(axis, idx, src)
def _segment_sum(src, seg, n):
    out = torch.zeros((n,) + src.shape[1:], dtype=src.dtype)
    return out.index_add_(0, seg, src)
def _pad(x, pw):
    flat = tuple(v for pair in reversed(pw) for v in pair)
    return torch.nn.functional.pad(x, flat)

kernel_name = 'concat_heads__softmax_full_mha__sliding_local_dilated__prompt'

def setup_inputs():

    _w = (lambda a: (lambda t: t.to(torch.bfloat16) if t.is_floating_point() else t)(torch.as_tensor(a)))
    def _A_setup():
        B, S, D = 1, 2048, 448
        return {
            "x": _w((lambda *s: torch.randn(*s, dtype=torch.bfloat16) * 0.2)(B, S, D)),
            "wqkv": _w((lambda *s: torch.randn(*s, dtype=torch.bfloat16) * 0.8)(D, 3 * D)),
            "wo": _w((lambda *s: torch.randn(*s, dtype=torch.bfloat16) * 0.2)(D, D)),
        }
    _A_in = _A_setup()

    def _B_setup():
        B, S, D = 1, 2048, 448
        return {
            "x": _w((lambda *s: torch.randn(*s, dtype=torch.bfloat16) * 0.4)(B, S, D)),
            "wqkv": _w((lambda *s: torch.randn(*s, dtype=torch.bfloat16) * 0.8)(D, 3 * D)),
            "wo": _w((lambda *s: torch.randn(*s, dtype=torch.bfloat16) * 0.1)(D, D)),
        }
    _B_in = _B_setup()

    return {
        "A_x": _A_in["x"],
        "A_wqkv": _A_in["wqkv"],
        "A_wo": _A_in["wo"],
        "B_x": _B_in["x"],
        "B_wqkv": _B_in["wqkv"],
        "B_wo": _B_in["wo"],
    }

def reference(A_x, A_wqkv, A_wo, B_x, B_wqkv, B_wo):
    def _A_ref(x, wqkv, wo):
        B, S, D = x.shape
        H = 16; Dh = D // H
        qkv = (lambda x, *d: x.permute(*d))((x @ wqkv).reshape(B, S, 3, H, Dh), 2, 0, 3, 1, 4)
        q, k, v = qkv[0], qkv[1], qkv[2]
        scale = Dh ** -0.5
        scores = torch.einsum("bhqd,bhkd->bhqk", q, k) * scale
        p = _softmax(scores, axis=-1)
        o = torch.einsum("bhqk,bhkd->bhqd", p, v)
        return (lambda x, *d: x.permute(*d))(o, 0, 2, 1, 3).reshape(B, S, D) @ wo

    def _B_ref(x, wqkv, wo):
        B, S, D = x.shape
        H = 16; Dh = D // H
        W, dil = 8, 2
        qkv = (lambda x, *d: x.permute(*d))((x @ wqkv).reshape(B, S, 3, H, Dh), 2, 0, 3, 1, 4)
        q, k, v = qkv[0], qkv[1], qkv[2]
        scale = Dh ** -0.5
        pos = torch.arange(S)
        off = torch.arange(W) * dil
        idx = pos[:, None] - off[None, :]
        mask = idx >= 0
        idx_c = torch.where(mask, idx, 0).reshape(-1)
        kg = k[:, :, idx_c, :].reshape(B, H, S, W, Dh)
        vg = v[:, :, idx_c, :].reshape(B, H, S, W, Dh)
        logits = torch.einsum("bhsd,bhswd->bhsw", q, kg) * scale
        logits = torch.where(mask[None, None, :, :], logits, -1e9)
        attn = _softmax(logits, axis=-1)
        o = torch.einsum("bhsw,bhswd->bhsd", attn, vg)
        return (lambda x, *d: x.permute(*d))(o, 0, 2, 1, 3).reshape(B, S, D) @ wo

    a = _A_ref(A_x, A_wqkv, A_wo)
    b = _B_ref(B_x, B_wqkv, B_wo)
    return torch.concatenate([a, b], axis=-1)
```

```asm
; @launch grid=(256,1,1) block=(512,1,1) lds=163840
.amdgcn_target "amdgcn-amd-amdhsa--gfx950"
.text
.globl concat_heads__softmax_full_mha__sliding_local_dilated__prompt_kernel
.p2align 8
.type concat_heads__softmax_full_mha__sliding_local_dilated__prompt_kernel,@function
concat_heads__softmax_full_mha__sliding_local_dilated__prompt_kernel:
    s_cmp_ge_u32 s2, 256
    s_cbranch_scc1 KERNEL_END
    s_load_dwordx16 s[80:95], s[0:1], 0
    s_load_dwordx2 s[96:97], s[0:1], 64
    v_lshrrev_b32 v2, 6, v0
    v_and_b32 v1, 63, v0
    v_readfirstlane_b32 s23, v2
    s_mov_b64 s[60:61], 0
    s_and_b32 s62, s23, 3
    s_and_b32 s3, s2, 7
    s_lshr_b32 s24, s2, 3
    s_lshr_b32 s20, s3, 2
    s_and_b32 s25, s3, 3
    s_and_b32 s27, s3, 1
    s_lshl_b32 s27, s27, 3
    s_and_b32 s21, s24, 7
    s_add_u32 s21, s21, s27
    s_lshr_b32 s27, s25, 1
    s_lshl_b32 s27, s27, 2
    s_lshr_b32 s22, s24, 3
    s_add_u32 s22, s22, s27
    s_lshl_b32 s26, s21, 2
    s_add_u32 s26, s26, s62
    s_cmp_ge_u32 s23, 4
    s_cbranch_scc1 HELPER
    s_and_b32 s27, s25, 1
    s_lshl_b32 s27, s27, 5
    s_add_u32 s27, s27, s24
    s_mul_i32 s27, s27, 28672
    v_mul_u32_u24 v20, 896, v1
    v_add_u32 v20, s27, v20
    v_cmp_lt_u32 vcc, 10, v1
    s_lshr_b32 s27, s25, 1
    s_mul_i32 s28, s27, 896
    s_add_u32 s28, s28, 4992
    v_cndmask_b32 v10, 0, 1, vcc
    v_mul_u32_u24 v11, 11, v10
    v_sub_u32 v11, v1, v11
    s_lshl_b32 s29, s24, 1
    v_add_u32 v10, s29, v10
    s_movk_i32 s29, 2688
    v_mul_lo_u32 v21, v10, s29
    v_lshl_add_u32 v21, v11, 7, v21
    s_mul_i32 s29, s27, 384
    s_add_u32 s29, s29, 3200
    v_cmp_gt_u32 vcc, 7, v11
    v_mov_b32 v10, s28
    v_mov_b32 v11, s29
    v_cndmask_b32 v10, v11, v10, vcc
    v_add_u32 v21, v21, v10
    s_waitcnt lgkmcnt(0)
    s_cmp_eq_u32 s20, 0
    s_cselect_b32 s6, s80, s86
    s_cselect_b32 s7, s81, s87
    s_cselect_b32 s28, s82, s88
    s_cselect_b32 s29, s83, s89
    s_mov_b32 s12, s6
    s_and_b32 s13, s7, 0xffff
    s_mov_b32 s14, 1835008
    s_mov_b32 s15, 0x20000
    s_sub_u32 s28, s28, 4096
    s_subb_u32 s29, s29, 0
    s_mov_b32 s16, s28
    s_and_b32 s17, s29, 0xffff
    s_mov_b32 s18, 1208320
    s_mov_b32 s19, 0x20000
    s_mov_b64 s[4:5], s[96:97]
    s_mov_b32 s8, s96
    s_and_b32 s9, s97, 0xffff
    s_mov_b32 s10, 33554432
    s_mov_b32 s11, 0x20000
    s_cmp_lg_u32 s62, 3
    s_cbranch_scc1 PF_SKIP0
    s_mov_b32 s3, 0
    s_mov_b32 exec_hi, 0
    buffer_load_dword v143, v20, s[12:15], 0 offen offset:0
    s_mov_b32 exec_lo, 0x3fffff
    buffer_load_dword v143, v21, s[16:19], s3 offen
    s_mov_b64 exec, -1
PF_SKIP0:
    s_cmp_lg_u32 s62, 0
    s_cbranch_scc1 PF_SKIP1
    s_mov_b32 s3, 172032
    s_mov_b32 exec_hi, 0
    buffer_load_dword v143, v20, s[12:15], 0 offen offset:128
    s_mov_b32 exec_lo, 0x3fffff
    buffer_load_dword v143, v21, s[16:19], s3 offen
    s_mov_b64 exec, -1
PF_SKIP1:
    s_cmp_lg_u32 s62, 1
    s_cbranch_scc1 PF_SKIP2
    s_mov_b32 s3, 344064
    s_mov_b32 exec_hi, 0
    buffer_load_dword v143, v20, s[12:15], 0 offen offset:256
    s_mov_b32 exec_lo, 0x3fffff
    buffer_load_dword v143, v21, s[16:19], s3 offen
    s_mov_b64 exec, -1
PF_SKIP2:
    s_cmp_lg_u32 s62, 2
    s_cbranch_scc1 PF_SKIP3
    s_mov_b32 s3, 516096
    s_mov_b32 exec_hi, 0
    buffer_load_dword v143, v20, s[12:15], 0 offen offset:384
    s_mov_b32 exec_lo, 0x3fffff
    buffer_load_dword v143, v21, s[16:19], s3 offen
    s_mov_b64 exec, -1
PF_SKIP3:
    s_cmp_lg_u32 s62, 3
    s_cbranch_scc1 WARM_SKIP
    v_lshlrev_b32 v22, 20, v1
    s_mov_b32 exec_lo, 0x1ffff
    s_mov_b32 exec_hi, 0
    buffer_load_dword v143, v22, s[8:11], 0 offen
    s_mov_b32 exec_lo, 0xf
    global_load_dword v143, v22, s[92:93]
    s_mov_b32 exec_lo, 1
    global_load_dword v143, v22, s[84:85]
    global_load_dword v143, v22, s[90:91]
    s_mov_b64 exec, -1
    s_getpc_b64 s[56:57]
    s_and_b32 s56, s56, 0xffffff00
    s_lshl_b32 s3, s24, 11
    v_lshlrev_b32 v22, 7, v1
    v_add_u32 v22, s3, v22
    v_cmp_gt_u32 vcc, 26624, v22
    s_nop 0
    s_and_b32 exec_lo, vcc_lo, 0xffff
    s_mov_b32 exec_hi, 0
    s_cbranch_execz WARM_NOCODE
    global_load_dword v143, v22, s[56:57]
WARM_NOCODE:
    s_mov_b64 exec, -1
WARM_SKIP:
    v_mov_b32 v140, v20
    v_mov_b32 v141, v21
    s_lshl_b32 s37, s62, 12
    v_and_b32 v2, 31, v1
    v_bfe_u32 v3, v1, 1, 3
    v_lshrrev_b32 v4, 5, v1
    v_xor_b32 v3, v3, v4
    v_lshlrev_b32 v2, 7, v2
    v_add_u32 v2, s37, v2
    v_xor_b32 v4, 0, v3
    v_lshl_add_u32 v4, v4, 4, v2
    v_xor_b32 v5, 2, v3
    v_lshl_add_u32 v5, v5, 4, v2
    v_xor_b32 v6, 4, v3
    v_lshl_add_u32 v6, v6, 4, v2
    v_xor_b32 v7, 6, v3
    v_lshl_add_u32 v7, v7, 4, v2
    v_lshrrev_b32 v2, 5, v1
    v_mul_u32_u24 v2, 2048, v2
    v_bfe_u32 v3, v1, 2, 2
    v_lshl_add_u32 v2, v3, 7, v2
    v_bfe_u32 v3, v1, 4, 1
    v_lshl_add_u32 v2, v3, 5, v2
    v_and_b32 v3, 3, v1
    v_lshl_add_u32 v2, v3, 3, v2
    v_add_u32 v2, 0, v2
    v_bfe_u32 v3, v1, 3, 1
    v_lshl_add_u32 v12, v3, 6, v2
    v_xor_b32 v3, 1, v3
    v_lshl_add_u32 v13, v3, 6, v2
    v_add_u32 v13, 8, v13
    v_add_u32 v8, 65536, v4
    v_add_u32 v9, 65536, v5
    v_add_u32 v10, 65536, v6
    v_add_u32 v11, 65536, v7
    v_add_u32 v14, 65536, v12
    v_add_u32 v15, 65536, v13
    v_lshrrev_b32 v2, 5, v1
    v_lshlrev_b32 v2, 11, v2
    v_bfe_u32 v3, v1, 2, 2
    v_lshl_add_u32 v2, v3, 8, v2
    v_bfe_u32 v22, v1, 4, 1
    v_lshl_add_u32 v2, v22, 5, v2
    v_and_b32 v22, 3, v1
    v_lshl_add_u32 v2, v22, 3, v2
    v_xor_b32 v22, 0, v3
    v_lshl_add_u32 v124, v22, 6, v2
    v_add_u32 v124, 16384, v124
    v_add_u32 v128, 65536, v124
    v_xor_b32 v22, 1, v3
    v_lshl_add_u32 v125, v22, 6, v2
    v_add_u32 v125, 16392, v125
    v_add_u32 v129, 65536, v125
    v_xor_b32 v22, 2, v3
    v_lshl_add_u32 v126, v22, 6, v2
    v_add_u32 v126, 16384, v126
    v_add_u32 v130, 65536, v126
    v_xor_b32 v22, 3, v3
    v_lshl_add_u32 v127, v22, 6, v2
    v_add_u32 v127, 16392, v127
    v_add_u32 v131, 65536, v127
    v_and_b32 v2, 31, v1
    v_mov_b32 v134, 0
    v_mov_b32 v3, 0x3f803f80
    v_cmp_eq_u32 vcc, 28, v2
    s_nop 1
    v_cndmask_b32 v134, v134, v3, vcc
    v_lshlrev_b32 v2, 4, v1
    s_and_b32 s27, s22, 3
    s_lshl_b32 s27, s27, 2
    s_lshl_b32 s28, s20, 4
    s_add_u32 s27, s27, s28
    s_lshl_b32 s27, s27, 6
    s_add_u32 s27, s27, s26
    s_lshl_b32 s40, s27, 12
    s_lshr_b32 s27, s22, 2
    s_lshl_b32 s27, s27, 11
    s_add_u32 s40, s40, s27
    s_add_u32 s40, s40, 4194304
    s_add_u32 s41, s40, 262144
    s_add_u32 s42, s40, 524288
    s_add_u32 s43, s40, 786432
    s_lshl_b32 s27, s22, 1
    s_add_u32 s27, s27, s28
    s_lshl_b32 s27, s27, 6
    s_add_u32 s27, s27, s26
    s_lshl_b32 s44, s27, 11
    s_add_u32 s45, s44, 131072
    s_mov_b32 s36, 0x3e8b97f6
    s_mov_b32 s37, 0x3e8b97f6
    s_lshl_b32 s31, s20, 3
    s_add_u32 s31, s31, s22
    s_lshl_b32 s31, s31, 4
    s_add_u32 s31, s31, s21
    s_lshl_b32 s31, s31, 3
    s_add_u32 s31, s31, 16777216
    v_mov_b32 v22, 159744
    v_mov_b32 v24, 0
    v_mov_b32 v25, 0
    ds_write_b64 v22, v[24:25]
    s_cmp_eq_u32 s20, 0
    s_mov_b32 s33, 139264
    s_cselect_b32 s33, 151552, s33
    s_lshl_b32 s27, s62, 11
    s_add_u32 s33, s33, s27
    v_add_u32 v3, s33, v2
    s_waitcnt lgkmcnt(0)
    s_cmp_ge_u32 s22, 4
    s_cbranch_scc1 P1V
    s_barrier
    s_cmp_lg_u32 s62, 3
    s_cbranch_scc1 PF_SKIP4
    s_mov_b32 s3, 688128
    s_mov_b32 exec_hi, 0
    buffer_load_dword v143, v140, s[12:15], 0 offen offset:512
    s_mov_b32 exec_lo, 0x3fffff
    buffer_load_dword v143, v141, s[16:19], s3 offen
    s_mov_b64 exec, -1
PF_SKIP4:
    s_cmp_lg_u32 s62, 0
    s_cbranch_scc1 PF_SKIP5
    s_mov_b32 s3, 860160
    s_mov_b32 exec_hi, 0
    buffer_load_dword v143, v140, s[12:15], 0 offen offset:640
    s_mov_b32 exec_lo, 0x3fffff
    buffer_load_dword v143, v141, s[16:19], s3 offen
    s_mov_b64 exec, -1
PF_SKIP5:
    s_cmp_lg_u32 s62, 1
    s_cbranch_scc1 PF_SKIP6
    s_mov_b32 s3, 1032192
    s_mov_b32 exec_hi, 0
    buffer_load_dword v143, v140, s[12:15], 0 offen offset:768
    s_mov_b32 exec_lo, 0x3fffff
    buffer_load_dword v143, v141, s[16:19], s3 offen
    s_mov_b64 exec, -1
PF_SKIP6:
    ds_read_b128 a[0:3], v4 offset:0
    ds_read_b64_tr_b16 v[80:81], v124 offset:0
    ds_read_b64_tr_b16 v[82:83], v124 offset:1024
    ds_read_b64_tr_b16 v[84:85], v125 offset:0
    ds_read_b64_tr_b16 v[86:87], v125 offset:1024
    ds_read_b64_tr_b16 v[88:89], v126 offset:0
    ds_read_b64_tr_b16 v[90:91], v126 offset:1024
    ds_read_b64_tr_b16 v[92:93], v127 offset:0
    ds_read_b64_tr_b16 v[94:95], v127 offset:1024
    ds_read_b128 a[4:7], v5 offset:0
    ds_read_b64_tr_b16 v[96:97], v124 offset:4096
    ds_read_b64_tr_b16 v[98:99], v124 offset:5120
    ds_read_b64_tr_b16 v[100:101], v125 offset:4096
    ds_read_b64_tr_b16 v[102:103], v125 offset:5120
    ds_read_b64_tr_b16 v[104:105], v126 offset:4096
    ds_read_b64_tr_b16 v[106:107], v126 offset:5120
    ds_read_b64_tr_b16 v[108:109], v127 offset:4096
    ds_read_b64_tr_b16 v[110:111], v127 offset:5120
    s_waitcnt lgkmcnt(15)
    v_mfma_f32_32x32x16_bf16 v[16:31], v[80:83], a[0:3], 0
    ds_read_b128 a[8:11], v6 offset:0
    ds_read_b64_tr_b16 v[112:113], v124 offset:8192
    ds_read_b64_tr_b16 v[114:115], v124 offset:9216
    s_waitcnt lgkmcnt(15)
    v_mfma_f32_32x32x16_bf16 v[32:47], v[84:87], a[0:3], 0
    ds_read_b64_tr_b16 v[116:117], v125 offset:8192
    ds_read_b64_tr_b16 v[118:119], v125 offset:9216
    s_waitcnt lgkmcnt(15)
    v_mfma_f32_32x32x16_bf16 v[48:63], v[88:91], a[0:3], 0
    ds_read_b64_tr_b16 v[120:121], v126 offset:8192
    ds_read_b64_tr_b16 v[122:123], v126 offset:9216
    s_waitcnt lgkmcnt(15)
    v_mfma_f32_32x32x16_bf16 v[64:79], v[92:95], a[0:3], 0
    ds_read_b64_tr_b16 v[80:81], v127 offset:8192
    ds_read_b64_tr_b16 v[82:83], v127 offset:9216
    s_waitcnt lgkmcnt(15)
    v_mfma_f32_32x32x16_bf16 v[16:31], v[96:99], a[4:7], v[16:31]
    ds_read_b128 a[12:15], v7 offset:0
    ds_read_b64_tr_b16 v[84:85], v124 offset:12288
    ds_read_b64_tr_b16 v[86:87], v124 offset:13312
    s_waitcnt lgkmcnt(15)
    v_mfma_f32_32x32x16_bf16 v[32:47], v[100:103], a[4:7], v[32:47]
    ds_read_b64_tr_b16 v[88:89], v125 offset:12288
    ds_read_b64_tr_b16 v[90:91], v125 offset:13312
    s_waitcnt lgkmcnt(15)
    v_mfma_f32_32x32x16_bf16 v[48:63], v[104:107], a[4:7], v[48:63]
    ds_read_b64_tr_b16 v[92:93], v126 offset:12288
    ds_read_b64_tr_b16 v[94:95], v126 offset:13312
    s_waitcnt lgkmcnt(15)
    v_mfma_f32_32x32x16_bf16 v[64:79], v[108:111], a[4:7], v[64:79]
    ds_read_b64_tr_b16 v[96:97], v127 offset:12288
    ds_read_b64_tr_b16 v[98:99], v127 offset:13312
    s_waitcnt lgkmcnt(15)
    v_mfma_f32_32x32x16_bf16 v[16:31], v[112:115], a[8:11], v[16:31]
    s_barrier
    ds_read_b128 a[16:19], v4 offset:32768
    ds_read_b64_tr_b16 v[100:101], v124 offset:32768
    ds_read_b64_tr_b16 v[102:103], v124 offset:33792
    s_waitcnt lgkmcnt(15)
    v_mfma_f32_32x32x16_bf16 v[32:47], v[116:119], a[8:11], v[32:47]
    ds_read_b64_tr_b16 v[104:105], v125 offset:32768
    ds_read_b64_tr_b16 v[106:107], v125 offset:33792
    s_waitcnt lgkmcnt(15)
    v_mfma_f32_32x32x16_bf16 v[48:63], v[120:123], a[8:11], v[48:63]
    ds_read_b64_tr_b16 v[108:109], v126 offset:32768
    ds_read_b64_tr_b16 v[110:111], v126 offset:33792
    s_waitcnt lgkmcnt(15)
    v_mfma_f32_32x32x16_bf16 v[64:79], v[80:83], a[8:11], v[64:79]
    ds_read_b64_tr_b16 v[112:113], v127 offset:32768
    ds_read_b64_tr_b16 v[114:115], v127 offset:33792
    s_waitcnt lgkmcnt(15)
    v_mfma_f32_32x32x16_bf16 v[16:31], v[84:87], a[12:15], v[16:31]
    ds_read_b128 a[20:23], v5 offset:32768
    ds_read_b64_tr_b16 v[116:117], v124 offset:36864
    ds_read_b64_tr_b16 v[118:119], v124 offset:37888
    s_waitcnt lgkmcnt(15)
    v_mfma_f32_32x32x16_bf16 v[32:47], v[88:91], a[12:15], v[32:47]
    ds_read_b64_tr_b16 v[120:121], v125 offset:36864
    ds_read_b64_tr_b16 v[122:123], v125 offset:37888
    s_waitcnt lgkmcnt(15)
    v_mfma_f32_32x32x16_bf16 v[48:63], v[92:95], a[12:15], v[48:63]
    ds_read_b64_tr_b16 v[80:81], v126 offset:36864
    ds_read_b64_tr_b16 v[82:83], v126 offset:37888
    s_waitcnt lgkmcnt(15)
    v_mfma_f32_32x32x16_bf16 v[64:79], v[96:99], a[12:15], v[64:79]
    ds_read_b64_tr_b16 v[84:85], v127 offset:36864
    ds_read_b64_tr_b16 v[86:87], v127 offset:37888
    s_waitcnt lgkmcnt(15)
    v_mfma_f32_32x32x16_bf16 v[16:31], v[100:103], a[16:19], v[16:31]
    ds_read_b128 a[24:27], v6 offset:32768
    ds_read_b64_tr_b16 v[88:89], v124 offset:40960
    ds_read_b64_tr_b16 v[90:91], v124 offset:41984
    s_waitcnt lgkmcnt(15)
    v_mfma_f32_32x32x16_bf16 v[32:47], v[104:107], a[16:19], v[32:47]
    ds_read_b64_tr_b16 v[92:93], v125 offset:40960
    ds_read_b64_tr_b16 v[94:95], v125 offset:41984
    s_waitcnt lgkmcnt(15)
    v_mfma_f32_32x32x16_bf16 v[48:63], v[108:111], a[16:19], v[48:63]
    ds_read_b64_tr_b16 v[96:97], v126 offset:40960
    ds_read_b64_tr_b16 v[98:99], v126 offset:41984
    s_waitcnt lgkmcnt(15)
    v_mfma_f32_32x32x16_bf16 v[64:79], v[112:115], a[16:19], v[64:79]
    ds_read_b64_tr_b16 v[100:101], v127 offset:40960
    ds_read_b64_tr_b16 v[102:103], v127 offset:41984
    s_waitcnt lgkmcnt(15)
    v_mfma_f32_32x32x16_bf16 v[16:31], v[116:119], a[20:23], v[16:31]
    ds_read_b128 a[28:31], v7 offset:32768
    ds_read_b64_tr_b16 v[104:105], v124 offset:45056
    ds_read_b64_tr_b16 v[106:107], v124 offset:46080
    s_waitcnt lgkmcnt(15)
    v_mfma_f32_32x32x16_bf16 v[32:47], v[120:123], a[20:23], v[32:47]
    ds_read_b64_tr_b16 v[108:109], v125 offset:45056
    ds_read_b64_tr_b16 v[110:111], v125 offset:46080
    s_waitcnt lgkmcnt(15)
    v_mfma_f32_32x32x16_bf16 v[48:63], v[80:83], a[20:23], v[48:63]
    ds_read_b64_tr_b16 v[112:113], v126 offset:45056
    ds_read_b64_tr_b16 v[114:115], v126 offset:46080
    s_waitcnt lgkmcnt(15)
    v_mfma_f32_32x32x16_bf16 v[64:79], v[84:87], a[20:23], v[64:79]
    ds_read_b64_tr_b16 v[116:117], v127 offset:45056
    ds_read_b64_tr_b16 v[118:119], v127 offset:46080
    s_waitcnt lgkmcnt(15)
    v_mfma_f32_32x32x16_bf16 v[16:31], v[88:91], a[24:27], v[16:31]
    s_barrier
    ds_read_b128 a[32:35], v8 offset:0
    ds_read_b64_tr_b16 v[120:121], v128 offset:0
    ds_read_b64_tr_b16 v[122:123], v128 offset:1024
    s_waitcnt lgkmcnt(15)
    v_mfma_f32_32x32x16_bf16 v[32:47], v[92:95], a[24:27], v[32:47]
    ds_read_b64_tr_b16 v[80:81], v129 offset:0
    ds_read_b64_tr_b16 v[82:83], v129 offset:1024
    s_waitcnt lgkmcnt(15)
    v_mfma_f32_32x32x16_bf16 v[48:63], v[96:99], a[24:27], v[48:63]
    ds_read_b64_tr_b16 v[84:85], v130 offset:0
    ds_read_b64_tr_b16 v[86:87], v130 offset:1024
    s_waitcnt lgkmcnt(15)
    v_mfma_f32_32x32x16_bf16 v[64:79], v[100:103], a[24:27], v[64:79]
    ds_read_b64_tr_b16 v[88:89], v131 offset:0
    ds_read_b64_tr_b16 v[90:91], v131 offset:1024
    s_waitcnt lgkmcnt(15)
    v_mfma_f32_32x32x16_bf16 v[16:31], v[104:107], a[28:31], v[16:31]
    ds_read_b128 a[36:39], v9 offset:0
    ds_read_b64_tr_b16 v[92:93], v128 offset:4096
    ds_read_b64_tr_b16 v[94:95], v128 offset:5120
    s_waitcnt lgkmcnt(15)
    v_mfma_f32_32x32x16_bf16 v[32:47], v[108:111], a[28:31], v[32:47]
    ds_read_b64_tr_b16 v[96:97], v129 offset:4096
    ds_read_b64_tr_b16 v[98:99], v129 offset:5120
    s_waitcnt lgkmcnt(15)
    v_mfma_f32_32x32x16_bf16 v[48:63], v[112:115], a[28:31], v[48:63]
    ds_read_b64_tr_b16 v[100:101], v130 offset:4096
    ds_read_b64_tr_b16 v[102:103], v130 offset:5120
    s_waitcnt lgkmcnt(15)
    v_mfma_f32_32x32x16_bf16 v[64:79], v[116:119], a[28:31], v[64:79]
    ds_read_b64_tr_b16 v[104:105], v131 offset:4096
    ds_read_b64_tr_b16 v[106:107], v131 offset:5120
    s_waitcnt lgkmcnt(15)
    v_mfma_f32_32x32x16_bf16 v[16:31], v[120:123], a[32:35], v[16:31]
    ds_read_b128 a[40:43], v10 offset:0
    ds_read_b64_tr_b16 v[108:109], v128 offset:8192
    ds_read_b64_tr_b16 v[110:111], v128 offset:9216
    s_waitcnt lgkmcnt(15)
    v_mfma_f32_32x32x16_bf16 v[32:47], v[80:83], a[32:35], v[32:47]
    ds_read_b64_tr_b16 v[112:113], v129 offset:8192
    ds_read_b64_tr_b16 v[114:115], v129 offset:9216
    s_waitcnt lgkmcnt(15)
    v_mfma_f32_32x32x16_bf16 v[48:63], v[84:87], a[32:35], v[48:63]
    ds_read_b64_tr_b16 v[116:117], v130 offset:8192
    ds_read_b64_tr_b16 v[118:119], v130 offset:9216
    s_waitcnt lgkmcnt(15)
    v_mfma_f32_32x32x16_bf16 v[64:79], v[88:91], a[32:35], v[64:79]
    ds_read_b64_tr_b16 v[120:121], v131 offset:8192
    ds_read_b64_tr_b16 v[122:123], v131 offset:9216
    s_waitcnt lgkmcnt(15)
    v_mfma_f32_32x32x16_bf16 v[16:31], v[92:95], a[36:39], v[16:31]
    ds_read_b128 a[44:47], v11 offset:0
    ds_read_b64_tr_b16 v[80:81], v128 offset:12288
    ds_read_b64_tr_b16 v[82:83], v128 offset:13312
    s_waitcnt lgkmcnt(15)
    v_mfma_f32_32x32x16_bf16 v[32:47], v[96:99], a[36:39], v[32:47]
    ds_read_b64_tr_b16 v[84:85], v129 offset:12288
    ds_read_b64_tr_b16 v[86:87], v129 offset:13312
    s_waitcnt lgkmcnt(15)
    v_mfma_f32_32x32x16_bf16 v[48:63], v[100:103], a[36:39], v[48:63]
    ds_read_b64_tr_b16 v[88:89], v130 offset:12288
    ds_read_b64_tr_b16 v[90:91], v130 offset:13312
    s_waitcnt lgkmcnt(15)
    v_mfma_f32_32x32x16_bf16 v[64:79], v[104:107], a[36:39], v[64:79]
    ds_read_b64_tr_b16 v[92:93], v131 offset:12288
    ds_read_b64_tr_b16 v[94:95], v131 offset:13312
    s_waitcnt lgkmcnt(15)
    v_mfma_f32_32x32x16_bf16 v[16:31], v[108:111], a[40:43], v[16:31]
    s_barrier
    ds_read_b128 a[48:51], v8 offset:32768
    ds_read_b64_tr_b16 v[96:97], v128 offset:32768
    ds_read_b64_tr_b16 v[98:99], v128 offset:33792
    s_waitcnt lgkmcnt(15)
    v_mfma_f32_32x32x16_bf16 v[32:47], v[112:115], a[40:43], v[32:47]
    ds_read_b64_tr_b16 v[100:101], v129 offset:32768
    ds_read_b64_tr_b16 v[102:103], v129 offset:33792
    s_waitcnt lgkmcnt(15)
    v_mfma_f32_32x32x16_bf16 v[48:63], v[116:119], a[40:43], v[48:63]
    ds_read_b64_tr_b16 v[104:105], v130 offset:32768
    ds_read_b64_tr_b16 v[106:107], v130 offset:33792
    s_waitcnt lgkmcnt(15)
    v_mfma_f32_32x32x16_bf16 v[64:79], v[120:123], a[40:43], v[64:79]
    ds_read_b64_tr_b16 v[108:109], v131 offset:32768
    ds_read_b64_tr_b16 v[110:111], v131 offset:33792
    s_waitcnt lgkmcnt(15)
    v_mfma_f32_32x32x16_bf16 v[16:31], v[80:83], a[44:47], v[16:31]
    ds_read_b128 a[52:55], v9 offset:32768
    ds_read_b64_tr_b16 v[112:113], v128 offset:36864
    ds_read_b64_tr_b16 v[114:115], v128 offset:37888
    s_waitcnt lgkmcnt(15)
    v_mfma_f32_32x32x16_bf16 v[32:47], v[84:87], a[44:47], v[32:47]
    ds_read_b64_tr_b16 v[116:117], v129 offset:36864
    ds_read_b64_tr_b16 v[118:119], v129 offset:37888
    s_waitcnt lgkmcnt(15)
    v_mfma_f32_32x32x16_bf16 v[48:63], v[88:91], a[44:47], v[48:63]
    ds_read_b64_tr_b16 v[120:121], v130 offset:36864
    ds_read_b64_tr_b16 v[122:123], v130 offset:37888
    s_waitcnt lgkmcnt(15)
    v_mfma_f32_32x32x16_bf16 v[64:79], v[92:95], a[44:47], v[64:79]
    ds_read_b64_tr_b16 v[80:81], v131 offset:36864
    ds_read_b64_tr_b16 v[82:83], v131 offset:37888
    s_waitcnt lgkmcnt(15)
    v_mfma_f32_32x32x16_bf16 v[16:31], v[96:99], a[48:51], v[16:31]
    ds_read_b128 a[56:59], v10 offset:32768
    ds_read_b64_tr_b16 v[84:85], v128 offset:40960
    ds_read_b64_tr_b16 v[86:87], v128 offset:41984
    s_waitcnt lgkmcnt(15)
    v_mfma_f32_32x32x16_bf16 v[32:47], v[100:103], a[48:51], v[32:47]
    ds_read_b64_tr_b16 v[88:89], v129 offset:40960
    ds_read_b64_tr_b16 v[90:91], v129 offset:41984
    s_waitcnt lgkmcnt(15)
    v_mfma_f32_32x32x16_bf16 v[48:63], v[104:107], a[48:51], v[48:63]
    ds_read_b64_tr_b16 v[92:93], v130 offset:40960
    ds_read_b64_tr_b16 v[94:95], v130 offset:41984
    s_waitcnt lgkmcnt(15)
    v_mfma_f32_32x32x16_bf16 v[64:79], v[108:111], a[48:51], v[64:79]
    ds_read_b64_tr_b16 v[96:97], v131 offset:40960
    ds_read_b64_tr_b16 v[98:99], v131 offset:41984
    s_waitcnt lgkmcnt(15)
    v_mfma_f32_32x32x16_bf16 v[16:31], v[112:115], a[52:55], v[16:31]
    ds_read_b128 a[60:63], v11 offset:32768
    ds_read_b64_tr_b16 v[100:101], v128 offset:45056
    ds_read_b64_tr_b16 v[102:103], v128 offset:46080
    s_waitcnt lgkmcnt(15)
    v_mfma_f32_32x32x16_bf16 v[32:47], v[116:119], a[52:55], v[32:47]
    ds_read_b64_tr_b16 v[104:105], v129 offset:45056
    ds_read_b64_tr_b16 v[106:107], v129 offset:46080
    s_waitcnt lgkmcnt(15)
    v_mfma_f32_32x32x16_bf16 v[48:63], v[120:123], a[52:55], v[48:63]
    ds_read_b64_tr_b16 v[108:109], v130 offset:45056
    ds_read_b64_tr_b16 v[110:111], v130 offset:46080
    s_waitcnt lgkmcnt(15)
    v_mfma_f32_32x32x16_bf16 v[64:79], v[80:83], a[52:55], v[64:79]
    ds_read_b64_tr_b16 v[112:113], v131 offset:45056
    ds_read_b64_tr_b16 v[114:115], v131 offset:46080
    s_waitcnt lgkmcnt(15)
    v_mfma_f32_32x32x16_bf16 v[16:31], v[84:87], a[56:59], v[16:31]
    s_barrier
    ds_read_b128 a[64:67], v4 offset:0
    ds_read_b64_tr_b16 v[116:117], v124 offset:0
    ds_read_b64_tr_b16 v[118:119], v124 offset:1024
    s_waitcnt lgkmcnt(15)
    v_mfma_f32_32x32x16_bf16 v[32:47], v[88:91], a[56:59], v[32:47]
    ds_read_b64_tr_b16 v[120:121], v125 offset:0
    ds_read_b64_tr_b16 v[122:123], v125 offset:1024
    s_waitcnt lgkmcnt(15)
    v_mfma_f32_32x32x16_bf16 v[48:63], v[92:95], a[56:59], v[48:63]
    ds_read_b64_tr_b16 v[80:81], v126 offset:0
    ds_read_b64_tr_b16 v[82:83], v126 offset:1024
    s_waitcnt lgkmcnt(15)
    v_mfma_f32_32x32x16_bf16 v[64:79], v[96:99], a[56:59], v[64:79]
    ds_read_b64_tr_b16 v[84:85], v127 offset:0
    ds_read_b64_tr_b16 v[86:87], v127 offset:1024
    s_waitcnt lgkmcnt(15)
    v_mfma_f32_32x32x16_bf16 v[16:31], v[100:103], a[60:63], v[16:31]
    ds_read_b128 a[68:71], v5 offset:0
    ds_read_b64_tr_b16 v[88:89], v124 offset:4096
    ds_read_b64_tr_b16 v[90:91], v124 offset:5120
    s_waitcnt lgkmcnt(15)
    v_mfma_f32_32x32x16_bf16 v[32:47], v[104:107], a[60:63], v[32:47]
    ds_read_b64_tr_b16 v[92:93], v125 offset:4096
    ds_read_b64_tr_b16 v[94:95], v125 offset:5120
    s_waitcnt lgkmcnt(15)
    v_mfma_f32_32x32x16_bf16 v[48:63], v[108:111], a[60:63], v[48:63]
    ds_read_b64_tr_b16 v[96:97], v126 offset:4096
    ds_read_b64_tr_b16 v[98:99], v126 offset:5120
    s_waitcnt lgkmcnt(15)
    v_mfma_f32_32x32x16_bf16 v[64:79], v[112:115], a[60:63], v[64:79]
    ds_read_b64_tr_b16 v[100:101], v127 offset:4096
    ds_read_b64_tr_b16 v[102:103], v127 offset:5120
    s_waitcnt lgkmcnt(15)
    v_mfma_f32_32x32x16_bf16 v[16:31], v[116:119], a[64:67], v[16:31]
    ds_read_b128 a[72:75], v6 offset:0
    ds_read_b64_tr_b16 v[104:105], v124 offset:8192
    ds_read_b64_tr_b16 v[106:107], v124 offset:9216
    s_waitcnt lgkmcnt(15)
    v_mfma_f32_32x32x16_bf16 v[32:47], v[120:123], a[64:67], v[32:47]
    ds_read_b64_tr_b16 v[108:109], v125 offset:8192
    ds_read_b64_tr_b16 v[110:111], v125 offset:9216
    s_waitcnt lgkmcnt(15)
    v_mfma_f32_32x32x16_bf16 v[48:63], v[80:83], a[64:67], v[48:63]
    ds_read_b64_tr_b16 v[112:113], v126 offset:8192
    ds_read_b64_tr_b16 v[114:115], v126 offset:9216
    s_waitcnt lgkmcnt(15)
    v_mfma_f32_32x32x16_bf16 v[64:79], v[84:87], a[64:67], v[64:79]
    ds_read_b64_tr_b16 v[116:117], v127 offset:8192
    ds_read_b64_tr_b16 v[118:119], v127 offset:9216
    s_waitcnt lgkmcnt(15)
    v_mfma_f32_32x32x16_bf16 v[16:31], v[88:91], a[68:71], v[16:31]
    ds_read_b128 a[76:79], v7 offset:0
    ds_read_b64_tr_b16 v[120:121], v124 offset:12288
    ds_read_b64_tr_b16 v[122:123], v124 offset:13312
    s_waitcnt lgkmcnt(15)
    v_mfma_f32_32x32x16_bf16 v[32:47], v[92:95], a[68:71], v[32:47]
    ds_read_b64_tr_b16 v[80:81], v125 offset:12288
    ds_read_b64_tr_b16 v[82:83], v125 offset:13312
    s_waitcnt lgkmcnt(15)
    v_mfma_f32_32x32x16_bf16 v[48:63], v[96:99], a[68:71], v[48:63]
    ds_read_b64_tr_b16 v[84:85], v126 offset:12288
    ds_read_b64_tr_b16 v[86:87], v126 offset:13312
    s_waitcnt lgkmcnt(15)
    v_mfma_f32_32x32x16_bf16 v[64:79], v[100:103], a[68:71], v[64:79]
    ds_read_b64_tr_b16 v[88:89], v127 offset:12288
    ds_read_b64_tr_b16 v[90:91], v127 offset:13312
    s_waitcnt lgkmcnt(15)
    v_mfma_f32_32x32x16_bf16 v[16:31], v[104:107], a[72:75], v[16:31]
    s_barrier
    ds_read_b128 a[80:83], v4 offset:32768
    ds_read_b64_tr_b16 v[92:93], v124 offset:32768
    ds_read_b64_tr_b16 v[94:95], v124 offset:33792
    s_waitcnt lgkmcnt(15)
    v_mfma_f32_32x32x16_bf16 v[32:47], v[108:111], a[72:75], v[32:47]
    ds_read_b64_tr_b16 v[96:97], v125 offset:32768
    ds_read_b64_tr_b16 v[98:99], v125 offset:33792
    s_waitcnt lgkmcnt(15)
    v_mfma_f32_32x32x16_bf16 v[48:63], v[112:115], a[72:75], v[48:63]
    ds_read_b64_tr_b16 v[100:101], v126 offset:32768
    ds_read_b64_tr_b16 v[102:103], v126 offset:33792
    s_waitcnt lgkmcnt(15)
    v_mfma_f32_32x32x16_bf16 v[64:79], v[116:119], a[72:75], v[64:79]
    ds_read_b64_tr_b16 v[104:105], v127 offset:32768
    ds_read_b64_tr_b16 v[106:107], v127 offset:33792
    s_waitcnt lgkmcnt(15)
    v_mfma_f32_32x32x16_bf16 v[16:31], v[120:123], a[76:79], v[16:31]
    ds_read_b128 a[84:87], v5 offset:32768
    ds_read_b64_tr_b16 v[108:109], v124 offset:36864
    ds_read_b64_tr_b16 v[110:111], v124 offset:37888
    s_waitcnt lgkmcnt(15)
    v_mfma_f32_32x32x16_bf16 v[32:47], v[80:83], a[76:79], v[32:47]
    ds_read_b64_tr_b16 v[112:113], v125 offset:36864
    ds_read_b64_tr_b16 v[114:115], v125 offset:37888
    s_waitcnt lgkmcnt(15)
    v_mfma_f32_32x32x16_bf16 v[48:63], v[84:87], a[76:79], v[48:63]
    ds_read_b64_tr_b16 v[116:117], v126 offset:36864
    ds_read_b64_tr_b16 v[118:119], v126 offset:37888
    s_waitcnt lgkmcnt(15)
    v_mfma_f32_32x32x16_bf16 v[64:79], v[88:91], a[76:79], v[64:79]
    ds_read_b64_tr_b16 v[120:121], v127 offset:36864
    ds_read_b64_tr_b16 v[122:123], v127 offset:37888
    s_waitcnt lgkmcnt(15)
    v_mfma_f32_32x32x16_bf16 v[16:31], v[92:95], a[80:83], v[16:31]
    ds_read_b128 a[88:91], v6 offset:32768
    ds_read_b64_tr_b16 v[80:81], v124 offset:40960
    ds_read_b64_tr_b16 v[82:83], v124 offset:41984
    s_waitcnt lgkmcnt(15)
    v_mfma_f32_32x32x16_bf16 v[32:47], v[96:99], a[80:83], v[32:47]
    ds_read_b64_tr_b16 v[84:85], v125 offset:40960
    ds_read_b64_tr_b16 v[86:87], v125 offset:41984
    s_waitcnt lgkmcnt(15)
    v_mfma_f32_32x32x16_bf16 v[48:63], v[100:103], a[80:83], v[48:63]
    ds_read_b64_tr_b16 v[88:89], v126 offset:40960
    ds_read_b64_tr_b16 v[90:91], v126 offset:41984
    s_waitcnt lgkmcnt(15)
    v_mfma_f32_32x32x16_bf16 v[64:79], v[104:107], a[80:83], v[64:79]
    ds_read_b64_tr_b16 v[92:93], v127 offset:40960
    ds_read_b64_tr_b16 v[94:95], v127 offset:41984
    s_waitcnt lgkmcnt(15)
    v_mfma_f32_32x32x16_bf16 v[16:31], v[108:111], a[84:87], v[16:31]
    ds_read_b128 a[92:95], v7 offset:32768
    ds_read_b64_tr_b16 v[96:97], v124 offset:45056
    ds_read_b64_tr_b16 v[98:99], v124 offset:46080
    s_waitcnt lgkmcnt(15)
    v_mfma_f32_32x32x16_bf16 v[32:47], v[112:115], a[84:87], v[32:47]
    ds_read_b64_tr_b16 v[100:101], v125 offset:45056
    ds_read_b64_tr_b16 v[102:103], v125 offset:46080
    s_waitcnt lgkmcnt(15)
    v_mfma_f32_32x32x16_bf16 v[48:63], v[116:119], a[84:87], v[48:63]
    ds_read_b64_tr_b16 v[104:105], v126 offset:45056
    ds_read_b64_tr_b16 v[106:107], v126 offset:46080
    s_waitcnt lgkmcnt(15)
    v_mfma_f32_32x32x16_bf16 v[64:79], v[120:123], a[84:87], v[64:79]
    ds_read_b64_tr_b16 v[108:109], v127 offset:45056
    ds_read_b64_tr_b16 v[110:111], v127 offset:46080
    s_waitcnt lgkmcnt(15)
    v_mfma_f32_32x32x16_bf16 v[16:31], v[80:83], a[88:91], v[16:31]
    s_barrier
    ds_read_b128 a[96:99], v8 offset:0
    ds_read_b64_tr_b16 v[112:113], v128 offset:0
    ds_read_b64_tr_b16 v[114:115], v128 offset:1024
    s_waitcnt lgkmcnt(15)
    v_mfma_f32_32x32x16_bf16 v[32:47], v[84:87], a[88:91], v[32:47]
    ds_read_b64_tr_b16 v[116:117], v129 offset:0
    ds_read_b64_tr_b16 v[118:119], v129 offset:1024
    s_waitcnt lgkmcnt(15)
    v_mfma_f32_32x32x16_bf16 v[48:63], v[88:91], a[88:91], v[48:63]
    ds_read_b64_tr_b16 v[120:121], v130 offset:0
    ds_read_b64_tr_b16 v[122:123], v130 offset:1024
    v_mov_b32 v138, 0
    global_load_dwordx2 v[136:137], v138, s[94:95] sc1
    s_waitcnt lgkmcnt(15)
    v_mfma_f32_32x32x16_bf16 v[64:79], v[92:95], a[88:91], v[64:79]
    ds_read_b64_tr_b16 v[80:81], v131 offset:0
    ds_read_b64_tr_b16 v[82:83], v131 offset:1024
    s_waitcnt lgkmcnt(15)
    v_mfma_f32_32x32x16_bf16 v[16:31], v[96:99], a[92:95], v[16:31]
    ds_read_b128 a[100:103], v9 offset:0
    ds_read_b64_tr_b16 v[84:85], v128 offset:4096
    ds_read_b64_tr_b16 v[86:87], v128 offset:5120
    s_waitcnt lgkmcnt(15)
    v_mfma_f32_32x32x16_bf16 v[32:47], v[100:103], a[92:95], v[32:47]
    ds_read_b64_tr_b16 v[88:89], v129 offset:4096
    ds_read_b64_tr_b16 v[90:91], v129 offset:5120
    s_waitcnt lgkmcnt(15)
    v_mfma_f32_32x32x16_bf16 v[48:63], v[104:107], a[92:95], v[48:63]
    ds_read_b64_tr_b16 v[92:93], v130 offset:4096
    ds_read_b64_tr_b16 v[94:95], v130 offset:5120
    s_waitcnt lgkmcnt(15)
    v_mfma_f32_32x32x16_bf16 v[64:79], v[108:111], a[92:95], v[64:79]
    ds_read_b64_tr_b16 v[96:97], v131 offset:4096
    ds_read_b64_tr_b16 v[98:99], v131 offset:5120
    s_waitcnt lgkmcnt(15)
    v_mfma_f32_32x32x16_bf16 v[16:31], v[112:115], a[96:99], v[16:31]
    ds_read_b128 a[104:107], v10 offset:0
    ds_read_b64_tr_b16 v[100:101], v128 offset:8192
    ds_read_b64_tr_b16 v[102:103], v128 offset:9216
    s_waitcnt lgkmcnt(15)
    v_mfma_f32_32x32x16_bf16 v[32:47], v[116:119], a[96:99], v[32:47]
    ds_read_b64_tr_b16 v[104:105], v129 offset:8192
    ds_read_b64_tr_b16 v[106:107], v129 offset:9216
    s_waitcnt lgkmcnt(15)
    v_mfma_f32_32x32x16_bf16 v[48:63], v[120:123], a[96:99], v[48:63]
    ds_read_b64_tr_b16 v[108:109], v130 offset:8192
    ds_read_b64_tr_b16 v[110:111], v130 offset:9216
    s_waitcnt lgkmcnt(15)
    v_mfma_f32_32x32x16_bf16 v[64:79], v[80:83], a[96:99], v[64:79]
    ds_read_b64_tr_b16 v[112:113], v131 offset:8192
    ds_read_b64_tr_b16 v[114:115], v131 offset:9216
    s_waitcnt lgkmcnt(15)
    v_mfma_f32_32x32x16_bf16 v[16:31], v[84:87], a[100:103], v[16:31]
    ds_read_b128 a[108:111], v11 offset:0
    ds_read_b64_tr_b16 v[116:117], v128 offset:12288
    ds_read_b64_tr_b16 v[118:119], v128 offset:13312
    s_waitcnt lgkmcnt(15)
    v_mfma_f32_32x32x16_bf16 v[32:47], v[88:91], a[100:103], v[32:47]
    ds_read_b64_tr_b16 v[120:121], v129 offset:12288
    ds_read_b64_tr_b16 v[122:123], v129 offset:13312
    s_waitcnt lgkmcnt(15)
    v_mfma_f32_32x32x16_bf16 v[48:63], v[92:95], a[100:103], v[48:63]
    ds_read_b64_tr_b16 v[80:81], v130 offset:12288
    ds_read_b64_tr_b16 v[82:83], v130 offset:13312
    s_waitcnt lgkmcnt(15)
    v_mfma_f32_32x32x16_bf16 v[64:79], v[96:99], a[100:103], v[64:79]
    ds_read_b64_tr_b16 v[84:85], v131 offset:12288
    ds_read_b64_tr_b16 v[86:87], v131 offset:13312
    s_waitcnt lgkmcnt(15)
    v_mfma_f32_32x32x16_bf16 v[16:31], v[100:103], a[104:107], v[16:31]
    s_barrier
    ds_read_b64_tr_b16 v[88:89], v15 offset:32768
    ds_read_b64_tr_b16 v[90:91], v15 offset:33280
    s_waitcnt lgkmcnt(15)
    v_mfma_f32_32x32x16_bf16 v[32:47], v[104:107], a[104:107], v[32:47]
    ds_read_b64_tr_b16 v[92:93], v15 offset:36864
    ds_read_b64_tr_b16 v[94:95], v15 offset:37376
    s_waitcnt lgkmcnt(15)
    v_mfma_f32_32x32x16_bf16 v[48:63], v[108:111], a[104:107], v[48:63]
    ds_read_b64_tr_b16 v[96:97], v15 offset:40960
    ds_read_b64_tr_b16 v[98:99], v15 offset:41472
    s_waitcnt lgkmcnt(15)
    v_mfma_f32_32x32x16_bf16 v[64:79], v[112:115], a[104:107], v[64:79]
    ds_read_b64_tr_b16 v[100:101], v15 offset:45056
    ds_read_b64_tr_b16 v[102:103], v15 offset:45568
    s_waitcnt lgkmcnt(14)
    v_mfma_f32_32x32x16_bf16 v[16:31], v[116:119], a[108:111], v[16:31]
    ds_read_b64_tr_b16 v[104:105], v15 offset:33792
    ds_read_b64_tr_b16 v[106:107], v15 offset:34304
    s_waitcnt lgkmcnt(14)
    v_mfma_f32_32x32x16_bf16 v[32:47], v[120:123], a[108:111], v[32:47]
    ds_read_b64_tr_b16 v[108:109], v15 offset:37888
    ds_read_b64_tr_b16 v[110:111], v15 offset:38400
    s_waitcnt lgkmcnt(14)
    v_mfma_f32_32x32x16_bf16 v[48:63], v[80:83], a[108:111], v[48:63]
    ds_read_b64_tr_b16 v[112:113], v15 offset:41984
    ds_read_b64_tr_b16 v[114:115], v15 offset:42496
    s_waitcnt lgkmcnt(14)
    v_mfma_f32_32x32x16_bf16 v[64:79], v[84:87], a[108:111], v[64:79]
    ds_read_b64_tr_b16 v[116:117], v15 offset:46080
    ds_read_b64_tr_b16 v[118:119], v15 offset:46592
    v_cvt_pk_bf16_f32 v16, v16, v17
    v_cvt_pk_bf16_f32 v17, v18, v19
    v_cvt_pk_bf16_f32 v18, v20, v21
    v_cvt_pk_bf16_f32 v19, v22, v23
    v_cvt_pk_bf16_f32 v20, v24, v25
    v_cvt_pk_bf16_f32 v21, v26, v27
    v_cvt_pk_bf16_f32 v22, v28, v29
    v_cvt_pk_bf16_f32 v23, v30, v31
    buffer_store_dwordx4 v[16:19], v2, s[8:11], s40 offen sc0 sc1
    s_mov_b32 exec_lo, 0
    v_mov_b32 v22, 0x3f803f80
    v_mov_b32 v23, 0x3f80
    s_mov_b32 exec_lo, -1
    buffer_store_dwordx4 v[20:23], v2, s[8:11], s40 offen offset:1024 sc0 sc1
    v_cvt_pk_bf16_f32 v24, v32, v33
    v_cvt_pk_bf16_f32 v25, v34, v35
    v_cvt_pk_bf16_f32 v26, v36, v37
    v_cvt_pk_bf16_f32 v27, v38, v39
    v_cvt_pk_bf16_f32 v28, v40, v41
    v_cvt_pk_bf16_f32 v29, v42, v43
    v_cvt_pk_bf16_f32 v30, v44, v45
    v_cvt_pk_bf16_f32 v31, v46, v47
    buffer_store_dwordx4 v[24:27], v2, s[8:11], s41 offen sc0 sc1
    s_mov_b32 exec_lo, 0
    v_mov_b32 v30, 0x3f803f80
    v_mov_b32 v31, 0x3f80
    s_mov_b32 exec_lo, -1
    buffer_store_dwordx4 v[28:31], v2, s[8:11], s41 offen offset:1024 sc0 sc1
    v_cvt_pk_bf16_f32 v32, v48, v49
    v_cvt_pk_bf16_f32 v33, v50, v51
    v_cvt_pk_bf16_f32 v34, v52, v53
    v_cvt_pk_bf16_f32 v35, v54, v55
    v_cvt_pk_bf16_f32 v36, v56, v57
    v_cvt_pk_bf16_f32 v37, v58, v59
    v_cvt_pk_bf16_f32 v38, v60, v61
    v_cvt_pk_bf16_f32 v39, v62, v63
    v_cvt_pk_bf16_f32 v40, v64, v65
    v_cvt_pk_bf16_f32 v41, v66, v67
    v_cvt_pk_bf16_f32 v42, v68, v69
    v_cvt_pk_bf16_f32 v43, v70, v71
    v_cvt_pk_bf16_f32 v44, v72, v73
    v_cvt_pk_bf16_f32 v45, v74, v75
    v_cvt_pk_bf16_f32 v46, v76, v77
    v_cvt_pk_bf16_f32 v47, v78, v79
    buffer_store_dwordx4 v[32:35], v2, s[8:11], s42 offen sc0 sc1
    s_waitcnt lgkmcnt(14)
    v_mfma_f32_32x32x16_bf16 v[64:79], v[88:91], a[0:3], 0
    ds_read_b64_tr_b16 v[120:121], v15 offset:49152
    ds_read_b64_tr_b16 v[122:123], v15 offset:49664
    s_mov_b32 exec_lo, 0
    v_mov_b32 v38, 0x3f803f80
    v_mov_b32 v39, 0x3f80
    s_mov_b32 exec_lo, -1
    s_waitcnt lgkmcnt(14)
    v_mfma_f32_32x32x16_bf16 v[64:79], v[92:95], a[4:7], v[64:79]
    ds_read_b64_tr_b16 v[80:81], v15 offset:53248
    ds_read_b64_tr_b16 v[82:83], v15 offset:53760
    buffer_store_dwordx4 v[36:39], v2, s[8:11], s42 offen offset:1024 sc0 sc1
    s_waitcnt lgkmcnt(14)
    v_mfma_f32_32x32x16_bf16 v[64:79], v[96:99], a[8:11], v[64:79]
    ds_read_b64_tr_b16 v[84:85], v15 offset:57344
    ds_read_b64_tr_b16 v[86:87], v15 offset:57856
    buffer_store_dwordx4 v[40:43], v2, s[8:11], s43 offen sc0 sc1
    s_waitcnt lgkmcnt(14)
    v_mfma_f32_32x32x16_bf16 v[64:79], v[100:103], a[12:15], v[64:79]
    ds_read_b64_tr_b16 v[88:89], v15 offset:61440
    ds_read_b64_tr_b16 v[90:91], v15 offset:61952
    s_mov_b32 exec_lo, 0
    v_mov_b32 v46, 0x3f803f80
    v_mov_b32 v47, 0x3f80
    s_mov_b32 exec_lo, -1
    s_waitcnt lgkmcnt(14)
    v_mfma_f32_32x32x16_bf16 v[64:79], v[104:107], a[16:19], v[64:79]
    ds_read_b64_tr_b16 v[92:93], v15 offset:50176
    ds_read_b64_tr_b16 v[94:95], v15 offset:50688
    buffer_store_dwordx4 v[44:47], v2, s[8:11], s43 offen offset:1024 sc0 sc1
    s_waitcnt lgkmcnt(14)
    v_mfma_f32_32x32x16_bf16 v[64:79], v[108:111], a[20:23], v[64:79]
    ds_read_b64_tr_b16 v[96:97], v15 offset:54272
    ds_read_b64_tr_b16 v[98:99], v15 offset:54784
    s_waitcnt lgkmcnt(14)
    v_mfma_f32_32x32x16_bf16 v[64:79], v[112:115], a[24:27], v[64:79]
    ds_read_b64_tr_b16 v[100:101], v15 offset:58368
    ds_read_b64_tr_b16 v[102:103], v15 offset:58880
    s_waitcnt lgkmcnt(14)
    v_mfma_f32_32x32x16_bf16 v[64:79], v[116:119], a[28:31], v[64:79]
    ds_read_b64_tr_b16 v[104:105], v15 offset:62464
    ds_read_b64_tr_b16 v[106:107], v15 offset:62976
    s_waitcnt lgkmcnt(14)
    v_mfma_f32_32x32x16_bf16 v[64:79], v[120:123], a[32:35], v[64:79]
    s_barrier
    ds_read_b64_tr_b16 v[108:109], v13 offset:0
    ds_read_b64_tr_b16 v[110:111], v13 offset:512
    s_waitcnt lgkmcnt(14)
    v_mfma_f32_32x32x16_bf16 v[64:79], v[80:83], a[36:39], v[64:79]
    ds_read_b64_tr_b16 v[112:113], v13 offset:4096
    ds_read_b64_tr_b16 v[114:115], v13 offset:4608
    s_waitcnt lgkmcnt(14)
    v_mfma_f32_32x32x16_bf16 v[64:79], v[84:87], a[40:43], v[64:79]
    ds_read_b64_tr_b16 v[116:117], v13 offset:8192
    ds_read_b64_tr_b16 v[118:119], v13 offset:8704
    s_waitcnt lgkmcnt(14)
    v_mfma_f32_32x32x16_bf16 v[64:79], v[88:91], a[44:47], v[64:79]
    ds_read_b64_tr_b16 v[120:121], v13 offset:12288
    ds_read_b64_tr_b16 v[122:123], v13 offset:12800
    s_waitcnt lgkmcnt(14)
    v_mfma_f32_32x32x16_bf16 v[64:79], v[92:95], a[48:51], v[64:79]
    ds_read_b64_tr_b16 v[80:81], v13 offset:1024
    ds_read_b64_tr_b16 v[82:83], v13 offset:1536
    s_waitcnt lgkmcnt(14)
    v_mfma_f32_32x32x16_bf16 v[64:79], v[96:99], a[52:55], v[64:79]
    ds_read_b64_tr_b16 v[84:85], v13 offset:5120
    ds_read_b64_tr_b16 v[86:87], v13 offset:5632
    s_waitcnt lgkmcnt(14)
    v_mfma_f32_32x32x16_bf16 v[64:79], v[100:103], a[56:59], v[64:79]
    ds_read_b64_tr_b16 v[88:89], v13 offset:9216
    ds_read_b64_tr_b16 v[90:91], v13 offset:9728
    s_waitcnt lgkmcnt(14)
    v_mfma_f32_32x32x16_bf16 v[64:79], v[104:107], a[60:63], v[64:79]
    ds_read_b64_tr_b16 v[92:93], v13 offset:13312
    ds_read_b64_tr_b16 v[94:95], v13 offset:13824
    s_waitcnt lgkmcnt(14)
    v_mfma_f32_32x32x16_bf16 v[64:79], v[108:111], a[64:67], v[64:79]
    ds_read_b64_tr_b16 v[96:97], v13 offset:16384
    ds_read_b64_tr_b16 v[98:99], v13 offset:16896
    s_waitcnt lgkmcnt(14)
    v_mfma_f32_32x32x16_bf16 v[64:79], v[112:115], a[68:71], v[64:79]
    ds_read_b64_tr_b16 v[100:101], v13 offset:20480
    ds_read_b64_tr_b16 v[102:103], v13 offset:20992
    s_waitcnt lgkmcnt(14)
    v_mfma_f32_32x32x16_bf16 v[64:79], v[116:119], a[72:75], v[64:79]
    ds_read_b64_tr_b16 v[104:105], v13 offset:24576
    ds_read_b64_tr_b16 v[106:107], v13 offset:25088
    s_waitcnt lgkmcnt(14)
    v_mfma_f32_32x32x16_bf16 v[64:79], v[120:123], a[76:79], v[64:79]
    ds_read_b64_tr_b16 v[108:109], v13 offset:28672
    ds_read_b64_tr_b16 v[110:111], v13 offset:29184
    s_waitcnt lgkmcnt(14)
    v_mfma_f32_32x32x16_bf16 v[64:79], v[80:83], a[80:83], v[64:79]
    ds_read_b64_tr_b16 v[112:113], v14 offset:32768
    ds_read_b64_tr_b16 v[114:115], v14 offset:33280
    s_waitcnt lgkmcnt(14)
    v_mfma_f32_32x32x16_bf16 v[64:79], v[84:87], a[84:87], v[64:79]
    ds_read_b64_tr_b16 v[116:117], v14 offset:36864
    ds_read_b64_tr_b16 v[118:119], v14 offset:37376
    s_waitcnt lgkmcnt(14)
    v_mfma_f32_32x32x16_bf16 v[64:79], v[88:91], a[88:91], v[64:79]
    ds_read_b64_tr_b16 v[120:121], v14 offset:40960
    ds_read_b64_tr_b16 v[122:123], v14 offset:41472
    s_waitcnt lgkmcnt(14)
    v_mfma_f32_32x32x16_bf16 v[64:79], v[92:95], a[92:95], v[64:79]
    ds_read_b64_tr_b16 v[80:81], v14 offset:45056
    ds_read_b64_tr_b16 v[82:83], v14 offset:45568
    s_waitcnt lgkmcnt(14)
    v_mfma_f32_32x32x16_bf16 v[64:79], v[96:99], a[96:99], v[64:79]
    ds_read_b64_tr_b16 v[84:85], v14 offset:33792
    ds_read_b64_tr_b16 v[86:87], v14 offset:34304
    s_waitcnt lgkmcnt(14)
    v_mfma_f32_32x32x16_bf16 v[64:79], v[100:103], a[100:103], v[64:79]
    ds_read_b64_tr_b16 v[88:89], v14 offset:37888
    ds_read_b64_tr_b16 v[90:91], v14 offset:38400
    s_waitcnt lgkmcnt(14)
    v_mfma_f32_32x32x16_bf16 v[64:79], v[104:107], a[104:107], v[64:79]
    ds_read_b64_tr_b16 v[92:93], v14 offset:41984
    ds_read_b64_tr_b16 v[94:95], v14 offset:42496
    s_waitcnt lgkmcnt(14)
    v_mfma_f32_32x32x16_bf16 v[64:79], v[108:111], a[108:111], v[64:79]
    ds_read_b64_tr_b16 v[96:97], v14 offset:46080
    ds_read_b64_tr_b16 v[98:99], v14 offset:46592
    s_mov_b32 s63, 0
TAG_L7:
    s_waitcnt vmcnt(0)
    v_readfirstlane_b32 s60, v136
    v_readfirstlane_b32 s61, v137
    s_nop 1
    s_cmp_lg_u32 s60, 0
    s_cbranch_scc1 TAG_OK7
    s_add_u32 s63, s63, 1
    s_cmp_gt_u32 s63, 131072
    s_cbranch_scc1 KERNEL_END
    global_load_dwordx2 v[136:137], v138, s[94:95] sc1
    s_branch TAG_L7
TAG_OK7:
    v_mov_b32 v136, 159744
    v_mov_b32 v137, 1
    s_mov_b32 exec_lo, 1
    s_mov_b32 exec_hi, 0
    ds_add_rtn_u32 v138, v136, v137
    s_mov_b64 exec, -1
    s_waitcnt lgkmcnt(0)
    v_readfirstlane_b32 s3, v138
    s_nop 1
    s_cmp_lg_u32 s3, 3
    s_cbranch_scc1 NOTLAST8
    v_mov_b32 v136, s60
    v_mov_b32 v137, s61
    v_lshlrev_b32 v138, 3, v1
    s_mov_b32 exec_lo, 1
    s_mov_b32 exec_hi, 0
    buffer_store_dwordx2 v[136:137], v138, s[8:11], s31 offen sc1
    s_mov_b64 exec, -1
NOTLAST8:
    v_mfma_f32_32x32x16_bf16 v[48:63], v[112:115], a[0:3], 0
    ds_read_b64_tr_b16 v[100:101], v14 offset:49152
    ds_read_b64_tr_b16 v[102:103], v14 offset:49664
    v_mfma_f32_32x32x16_bf16 v[48:63], v[116:119], a[4:7], v[48:63]
    ds_read_b64_tr_b16 v[104:105], v14 offset:53248
    ds_read_b64_tr_b16 v[106:107], v14 offset:53760
    v_mfma_f32_32x32x16_bf16 v[48:63], v[120:123], a[8:11], v[48:63]
    ds_read_b64_tr_b16 v[108:109], v14 offset:57344
    ds_read_b64_tr_b16 v[110:111], v14 offset:57856
    v_pk_mul_f32 v[64:65], v[64:65], s[36:37]
    v_pk_mul_f32 v[66:67], v[66:67], s[36:37]
    v_pk_mul_f32 v[68:69], v[68:69], s[36:37]
    v_pk_mul_f32 v[70:71], v[70:71], s[36:37]
    v_mfma_f32_32x32x16_bf16 v[48:63], v[80:83], a[12:15], v[48:63]
    ds_read_b64_tr_b16 v[112:113], v14 offset:61440
    ds_read_b64_tr_b16 v[114:115], v14 offset:61952
    v_pk_mul_f32 v[72:73], v[72:73], s[36:37]
    v_pk_mul_f32 v[74:75], v[74:75], s[36:37]
    v_pk_mul_f32 v[76:77], v[76:77], s[36:37]
    v_pk_mul_f32 v[78:79], v[78:79], s[36:37]
    v_mfma_f32_32x32x16_bf16 v[48:63], v[84:87], a[16:19], v[48:63]
    ds_read_b64_tr_b16 v[116:117], v14 offset:50176
    ds_read_b64_tr_b16 v[118:119], v14 offset:50688
    v_cvt_pk_bf16_f32 v64, v64, v65
    v_cvt_pk_bf16_f32 v65, v66, v67
    v_cvt_pk_bf16_f32 v66, v68, v69
    v_cvt_pk_bf16_f32 v67, v70, v71
    v_mfma_f32_32x32x16_bf16 v[48:63], v[88:91], a[20:23], v[48:63]
    ds_read_b64_tr_b16 v[120:121], v14 offset:54272
    ds_read_b64_tr_b16 v[122:123], v14 offset:54784
    v_cvt_pk_bf16_f32 v68, v72, v73
    v_cvt_pk_bf16_f32 v69, v74, v75
    v_cvt_pk_bf16_f32 v70, v76, v77
    v_cvt_pk_bf16_f32 v71, v78, v79
    v_mfma_f32_32x32x16_bf16 v[48:63], v[92:95], a[24:27], v[48:63]
    ds_read_b64_tr_b16 v[80:81], v14 offset:58368
    ds_read_b64_tr_b16 v[82:83], v14 offset:58880
    s_mov_b32 exec_lo, 0
    v_mov_b32 v70, 0
    v_mov_b32 v71, 0
    s_mov_b32 exec_lo, -1
    v_mfma_f32_32x32x16_bf16 v[48:63], v[96:99], a[28:31], v[48:63]
    ds_read_b64_tr_b16 v[84:85], v14 offset:62464
    ds_read_b64_tr_b16 v[86:87], v14 offset:62976
    buffer_store_dwordx4 v[64:67], v2, s[8:11], s45 offen sc0 sc1
    s_waitcnt lgkmcnt(14)
    v_mfma_f32_32x32x16_bf16 v[48:63], v[100:103], a[32:35], v[48:63]
    ds_read_b64_tr_b16 v[88:89], v12 offset:0
    ds_read_b64_tr_b16 v[90:91], v12 offset:512
    buffer_store_dwordx4 v[68:71], v2, s[8:11], s45 offen offset:1024 sc0 sc1
    s_waitcnt lgkmcnt(14)
    v_mfma_f32_32x32x16_bf16 v[48:63], v[104:107], a[36:39], v[48:63]
    ds_read_b64_tr_b16 v[92:93], v12 offset:4096
    ds_read_b64_tr_b16 v[94:95], v12 offset:4608
    s_waitcnt lgkmcnt(14)
    v_mfma_f32_32x32x16_bf16 v[48:63], v[108:111], a[40:43], v[48:63]
    ds_read_b64_tr_b16 v[96:97], v12 offset:8192
    ds_read_b64_tr_b16 v[98:99], v12 offset:8704
    s_waitcnt lgkmcnt(14)
    v_mfma_f32_32x32x16_bf16 v[48:63], v[112:115], a[44:47], v[48:63]
    ds_read_b64_tr_b16 v[100:101], v12 offset:12288
    ds_read_b64_tr_b16 v[102:103], v12 offset:12800
    s_waitcnt lgkmcnt(14)
    v_mfma_f32_32x32x16_bf16 v[48:63], v[116:119], a[48:51], v[48:63]
    ds_read_b64_tr_b16 v[104:105], v12 offset:1024
    ds_read_b64_tr_b16 v[106:107], v12 offset:1536
    s_waitcnt lgkmcnt(14)
    v_mfma_f32_32x32x16_bf16 v[48:63], v[120:123], a[52:55], v[48:63]
    ds_read_b64_tr_b16 v[108:109], v12 offset:5120
    ds_read_b64_tr_b16 v[110:111], v12 offset:5632
    s_waitcnt lgkmcnt(14)
    v_mfma_f32_32x32x16_bf16 v[48:63], v[80:83], a[56:59], v[48:63]
    ds_read_b64_tr_b16 v[112:113], v12 offset:9216
    ds_read_b64_tr_b16 v[114:115], v12 offset:9728
    s_waitcnt lgkmcnt(14)
    v_mfma_f32_32x32x16_bf16 v[48:63], v[84:87], a[60:63], v[48:63]
    ds_read_b64_tr_b16 v[116:117], v12 offset:13312
    ds_read_b64_tr_b16 v[118:119], v12 offset:13824
    s_waitcnt lgkmcnt(14)
    v_mfma_f32_32x32x16_bf16 v[48:63], v[88:91], a[64:67], v[48:63]
    ds_read_b64_tr_b16 v[120:121], v12 offset:16384
    ds_read_b64_tr_b16 v[122:123], v12 offset:16896
    s_waitcnt lgkmcnt(14)
    v_mfma_f32_32x32x16_bf16 v[48:63], v[92:95], a[68:71], v[48:63]
    ds_read_b64_tr_b16 v[80:81], v12 offset:20480
    ds_read_b64_tr_b16 v[82:83], v12 offset:20992
    s_waitcnt lgkmcnt(14)
    v_mfma_f32_32x32x16_bf16 v[48:63], v[96:99], a[72:75], v[48:63]
    ds_read_b64_tr_b16 v[84:85], v12 offset:24576
    ds_read_b64_tr_b16 v[86:87], v12 offset:25088
    s_waitcnt lgkmcnt(14)
    v_mfma_f32_32x32x16_bf16 v[48:63], v[100:103], a[76:79], v[48:63]
    ds_read_b64_tr_b16 v[88:89], v12 offset:28672
    ds_read_b64_tr_b16 v[90:91], v12 offset:29184
    s_waitcnt lgkmcnt(14)
    v_mfma_f32_32x32x16_bf16 v[48:63], v[104:107], a[80:83], v[48:63]
    s_waitcnt lgkmcnt(12)
    v_mfma_f32_32x32x16_bf16 v[48:63], v[108:111], a[84:87], v[48:63]
    s_waitcnt lgkmcnt(10)
    v_mfma_f32_32x32x16_bf16 v[48:63], v[112:115], a[88:91], v[48:63]
    s_waitcnt lgkmcnt(8)
    v_mfma_f32_32x32x16_bf16 v[48:63], v[116:119], a[92:95], v[48:63]
    s_add_u32 s31, s31, 2048
    s_cmp_lg_u32 s20, 0
    s_cbranch_scc1 NOQF9
    s_waitcnt vmcnt(0)
    v_mov_b32 v136, 159748
    v_mov_b32 v137, 1
    s_mov_b32 exec_lo, 1
    s_mov_b32 exec_hi, 0
    ds_add_rtn_u32 v138, v136, v137
    s_mov_b64 exec, -1
    s_waitcnt lgkmcnt(0)
    v_readfirstlane_b32 s3, v138
    s_nop 1
    s_cmp_lg_u32 s3, 3
    s_cbranch_scc1 NOTLAST10
    v_mov_b32 v136, s60
    v_mov_b32 v137, s61
    v_lshlrev_b32 v138, 3, v1
    s_mov_b32 exec_lo, 1
    s_mov_b32 exec_hi, 0
    buffer_store_dwordx2 v[136:137], v138, s[8:11], s31 offen sc1
    s_mov_b64 exec, -1
NOTLAST10:
NOQF9:
    s_waitcnt lgkmcnt(6)
    v_mfma_f32_32x32x16_bf16 v[48:63], v[120:123], a[96:99], v[48:63]
    s_waitcnt lgkmcnt(4)
    v_mfma_f32_32x32x16_bf16 v[48:63], v[80:83], a[100:103], v[48:63]
    s_waitcnt lgkmcnt(2)
    v_mfma_f32_32x32x16_bf16 v[48:63], v[84:87], a[104:107], v[48:63]
    s_waitcnt lgkmcnt(0)
    v_mfma_f32_32x32x16_bf16 v[48:63], v[88:91], a[108:111], v[48:63]
    s_nop 11
    v_pk_mul_f32 v[48:49], v[48:49], s[36:37]
    v_pk_mul_f32 v[50:51], v[50:51], s[36:37]
    v_pk_mul_f32 v[52:53], v[52:53], s[36:37]
    v_pk_mul_f32 v[54:55], v[54:55], s[36:37]
    v_pk_mul_f32 v[56:57], v[56:57], s[36:37]
    v_pk_mul_f32 v[58:59], v[58:59], s[36:37]
    v_pk_mul_f32 v[60:61], v[60:61], s[36:37]
    v_pk_mul_f32 v[62:63], v[62:63], s[36:37]
    v_cvt_pk_bf16_f32 v48, v48, v49
    v_cvt_pk_bf16_f32 v49, v50, v51
    v_cvt_pk_bf16_f32 v50, v52, v53
    v_cvt_pk_bf16_f32 v51, v54, v55
    v_cvt_pk_bf16_f32 v52, v56, v57
    v_cvt_pk_bf16_f32 v53, v58, v59
    v_cvt_pk_bf16_f32 v54, v60, v61
    v_cvt_pk_bf16_f32 v55, v62, v63
    s_mov_b32 exec_lo, 0
    v_mov_b32 v54, 0
    v_mov_b32 v55, 0
    s_mov_b32 exec_lo, -1
    ds_write_b128 v3, v[48:51]
    ds_write_b128 v3, v[52:55] offset:1024
    s_branch P1_DONE
HELPER:
    s_mul_i32 s35, s26, 28672
    s_mul_i32 s36, s62, 43008
    v_lshrrev_b32 v2, 3, v1
    v_lshrrev_b32 v3, 4, v1
    v_and_b32 v8, 7, v1
    v_xor_b32 v3, v3, v8
    v_mul_u32_u24 v9, 896, v2
    v_lshl_add_u32 v4, v3, 4, v9
    v_xor_b32 v3, 4, v3
    v_lshl_add_u32 v5, v3, 4, v9
    v_add_u32 v5, 6144, v5
    v_add_u32 v6, 12288, v4
    v_add_u32 v7, 12288, v5
    v_lshrrev_b32 v9, 4, v1
    v_bfe_u32 v3, v1, 2, 2
    v_xor_b32 v3, v3, v9
    v_mul_u32_u24 v11, 2688, v9
    v_lshrrev_b32 v9, 1, v3
    v_mul_u32_u24 v9, 112, v9
    v_and_b32 v3, 1, v3
    v_mul_u32_u24 v3, 48, v3
    v_add3_u32 v11, v11, v9, v3
    v_and_b32 v3, 3, v1
    v_lshl_add_u32 v11, v3, 4, v11
    s_mul_i32 s27, s22, 224
    s_add_u32 s27, s27, 4992
    v_add_u32 v11, s27, v11
    v_add_u32 v12, 9728, v11
    v_add_u32 v13, 19456, v11
    v_add_u32 v14, 29184, v11
    s_mul_i32 s27, s22, 112
    s_add_u32 s27, s27, 4096
    v_mul_u32_u24 v8, 2688, v2
    v_bfe_u32 v2, v1, 2, 1
    v_bfe_u32 v9, v1, 4, 1
    v_xor_b32 v2, v2, v9
    v_mul_u32_u24 v2, 48, v2
    v_lshl_add_u32 v2, v3, 4, v2
    v_add3_u32 v8, v8, v2, s27
    v_add_u32 v10, 19456, v8
    s_lshl_b32 s37, s62, 12
    s_waitcnt lgkmcnt(0)
    s_cmp_eq_u32 s20, 0
    s_cselect_b32 s6, s80, s86
    s_cselect_b32 s7, s81, s87
    s_cselect_b32 s28, s82, s88
    s_cselect_b32 s29, s83, s89
    s_mov_b32 s12, s6
    s_and_b32 s13, s7, 0xffff
    s_mov_b32 s14, 1835008
    s_mov_b32 s15, 0x20000
    s_sub_u32 s28, s28, 4096
    s_subb_u32 s29, s29, 0
    s_mov_b32 s16, s28
    s_and_b32 s17, s29, 0xffff
    s_mov_b32 s18, 1208320
    s_mov_b32 s19, 0x20000
    s_mov_b64 s[4:5], s[96:97]
    s_mov_b32 s8, s96
    s_and_b32 s9, s97, 0xffff
    s_mov_b32 s10, 33554432
    s_mov_b32 s11, 0x20000
    s_or_b32 s3, s2, s62
    s_cmp_lg_u32 s3, 0
    s_cbranch_scc1 NO_TAG_PUB
    s_memrealtime s[98:99]
    s_waitcnt lgkmcnt(0)
    s_or_b32 s98, s98, 1
    v_mov_b32 v24, s98
    v_mov_b32 v25, s99
    v_mov_b32 v26, 0
    s_mov_b32 exec_lo, 1
    s_mov_b32 exec_hi, 0
    global_store_dwordx2 v26, v[24:25], s[94:95] sc1
    s_mov_b64 exec, -1
NO_TAG_PUB:
    s_add_u32 m0, s37, 0
    s_add_u32 s27, s35, 0
    buffer_load_dwordx4 v4, s[12:15], s27 offen offset:0 lds
    buffer_load_dwordx4 v5, s[12:15], s27 offen offset:1024 lds
    buffer_load_dwordx4 v6, s[12:15], s27 offen offset:2048 lds
    buffer_load_dwordx4 v7, s[12:15], s27 offen offset:3072 lds
    s_add_u32 m0, s37, 16384
    s_add_u32 s27, s36, 0
    buffer_load_dwordx4 v11, s[16:19], s27 offen offset:0 lds
    buffer_load_dwordx4 v12, s[16:19], s27 offen offset:1024 lds
    buffer_load_dwordx4 v13, s[16:19], s27 offen offset:2048 lds
    buffer_load_dwordx4 v14, s[16:19], s27 offen offset:3072 lds
    s_add_u32 m0, s37, 32768
    s_add_u32 s27, s35, 128
    buffer_load_dwordx4 v4, s[12:15], s27 offen offset:0 lds
    buffer_load_dwordx4 v5, s[12:15], s27 offen offset:1024 lds
    buffer_load_dwordx4 v6, s[12:15], s27 offen offset:2048 lds
    buffer_load_dwordx4 v7, s[12:15], s27 offen offset:3072 lds
    s_add_u32 m0, s37, 49152
    s_add_u32 s27, s36, 172032
    buffer_load_dwordx4 v11, s[16:19], s27 offen offset:0 lds
    buffer_load_dwordx4 v12, s[16:19], s27 offen offset:1024 lds
    buffer_load_dwordx4 v13, s[16:19], s27 offen offset:2048 lds
    buffer_load_dwordx4 v14, s[16:19], s27 offen offset:3072 lds
    s_waitcnt vmcnt(8)
    s_barrier
    s_add_u32 m0, s37, 65536
    s_add_u32 s27, s35, 256
    buffer_load_dwordx4 v4, s[12:15], s27 offen offset:0 lds
    buffer_load_dwordx4 v5, s[12:15], s27 offen offset:1024 lds
    buffer_load_dwordx4 v6, s[12:15], s27 offen offset:2048 lds
    buffer_load_dwordx4 v7, s[12:15], s27 offen offset:3072 lds
    s_add_u32 m0, s37, 81920
    s_add_u32 s27, s36, 344064
    buffer_load_dwordx4 v11, s[16:19], s27 offen offset:0 lds
    buffer_load_dwordx4 v12, s[16:19], s27 offen offset:1024 lds
    buffer_load_dwordx4 v13, s[16:19], s27 offen offset:2048 lds
    buffer_load_dwordx4 v14, s[16:19], s27 offen offset:3072 lds
    s_waitcnt vmcnt(8)
    s_barrier
    s_add_u32 m0, s37, 98304
    s_add_u32 s27, s35, 384
    buffer_load_dwordx4 v4, s[12:15], s27 offen offset:0 lds
    buffer_load_dwordx4 v5, s[12:15], s27 offen offset:1024 lds
    buffer_load_dwordx4 v6, s[12:15], s27 offen offset:2048 lds
    buffer_load_dwordx4 v7, s[12:15], s27 offen offset:3072 lds
    s_add_u32 m0, s37, 114688
    s_add_u32 s27, s36, 516096
    buffer_load_dwordx4 v11, s[16:19], s27 offen offset:0 lds
    buffer_load_dwordx4 v12, s[16:19], s27 offen offset:1024 lds
    buffer_load_dwordx4 v13, s[16:19], s27 offen offset:2048 lds
    buffer_load_dwordx4 v14, s[16:19], s27 offen offset:3072 lds
    s_waitcnt vmcnt(8)
    s_barrier
    s_add_u32 m0, s37, 0
    s_add_u32 s27, s35, 512
    buffer_load_dwordx4 v4, s[12:15], s27 offen offset:0 lds
    buffer_load_dwordx4 v5, s[12:15], s27 offen offset:1024 lds
    buffer_load_dwordx4 v6, s[12:15], s27 offen offset:2048 lds
    buffer_load_dwordx4 v7, s[12:15], s27 offen offset:3072 lds
    s_add_u32 m0, s37, 16384
    s_add_u32 s27, s36, 688128
    buffer_load_dwordx4 v11, s[16:19], s27 offen offset:0 lds
    buffer_load_dwordx4 v12, s[16:19], s27 offen offset:1024 lds
    buffer_load_dwordx4 v13, s[16:19], s27 offen offset:2048 lds
    buffer_load_dwordx4 v14, s[16:19], s27 offen offset:3072 lds
    s_waitcnt vmcnt(8)
    s_barrier
    s_add_u32 m0, s37, 32768
    s_add_u32 s27, s35, 640
    buffer_load_dwordx4 v4, s[12:15], s27 offen offset:0 lds
    buffer_load_dwordx4 v5, s[12:15], s27 offen offset:1024 lds
    buffer_load_dwordx4 v6, s[12:15], s27 offen offset:2048 lds
    buffer_load_dwordx4 v7, s[12:15], s27 offen offset:3072 lds
    s_add_u32 m0, s37, 49152
    s_add_u32 s27, s36, 860160
    buffer_load_dwordx4 v11, s[16:19], s27 offen offset:0 lds
    buffer_load_dwordx4 v12, s[16:19], s27 offen offset:1024 lds
    buffer_load_dwordx4 v13, s[16:19], s27 offen offset:2048 lds
    buffer_load_dwordx4 v14, s[16:19], s27 offen offset:3072 lds
    s_waitcnt vmcnt(8)
    s_barrier
    s_add_u32 m0, s37, 65536
    s_add_u32 s27, s35, 768
    buffer_load_dwordx4 v4, s[12:15], s27 offen offset:0 lds
    buffer_load_dwordx4 v5, s[12:15], s27 offen offset:1024 lds
    buffer_load_dwordx4 v6, s[12:15], s27 offen offset:2048 lds
    buffer_load_dwordx4 v7, s[12:15], s27 offen offset:3072 lds
    s_add_u32 m0, s37, 81920
    s_add_u32 s27, s36, 1032192
    buffer_load_dwordx4 v11, s[16:19], s27 offen offset:0 lds
    buffer_load_dwordx4 v12, s[16:19], s27 offen offset:1024 lds
    buffer_load_dwordx4 v13, s[16:19], s27 offen offset:2048 lds
    buffer_load_dwordx4 v14, s[16:19], s27 offen offset:3072 lds
    s_waitcnt vmcnt(8)
    s_barrier
    s_add_u32 m0, s37, 98304
    s_add_u32 s27, s36, 0
    buffer_load_dwordx4 v8, s[16:19], s27 offen lds
    buffer_load_dwordx4 v10, s[16:19], s27 offen offset:2048 lds
    s_add_u32 m0, s37, 99328
    s_add_u32 s27, s36, 172032
    buffer_load_dwordx4 v8, s[16:19], s27 offen lds
    buffer_load_dwordx4 v10, s[16:19], s27 offen offset:2048 lds
    s_add_u32 m0, s37, 114688
    s_add_u32 s27, s36, 344064
    buffer_load_dwordx4 v8, s[16:19], s27 offen lds
    buffer_load_dwordx4 v10, s[16:19], s27 offen offset:2048 lds
    s_add_u32 m0, s37, 115712
    s_add_u32 s27, s36, 516096
    buffer_load_dwordx4 v8, s[16:19], s27 offen lds
    buffer_load_dwordx4 v10, s[16:19], s27 offen offset:2048 lds
    s_waitcnt vmcnt(8)
    s_barrier
    s_add_u32 m0, s37, 0
    s_add_u32 s27, s36, 688128
    buffer_load_dwordx4 v8, s[16:19], s27 offen lds
    buffer_load_dwordx4 v10, s[16:19], s27 offen offset:2048 lds
    s_add_u32 m0, s37, 1024
    s_add_u32 s27, s36, 860160
    buffer_load_dwordx4 v8, s[16:19], s27 offen lds
    buffer_load_dwordx4 v10, s[16:19], s27 offen offset:2048 lds
    s_add_u32 m0, s37, 16384
    s_add_u32 s27, s36, 1032192
    buffer_load_dwordx4 v8, s[16:19], s27 offen lds
    buffer_load_dwordx4 v10, s[16:19], s27 offen offset:2048 lds
    v_mov_b32 v26, 0
    global_load_dwordx2 v[24:25], v26, s[94:95] sc1
    s_waitcnt vmcnt(7)
    s_barrier
    s_waitcnt vmcnt(1)
    s_barrier
    s_cmp_eq_u32 s26, 0
    s_cselect_b64 s[58:59], 0, -1
    v_mov_b32 v2, 0xf149f2ca
    v_mov_b32 v3, 0
    s_mov_b32 s56, 0x5555
    s_mov_b32 s57, 0x55550
    v_cndmask_b32 v108, v2, v3, s[56:57]
    s_mov_b32 s56, 0xaaaa
    s_mov_b32 s57, 0xaaaa0
    v_cndmask_b32 v109, v2, v3, s[56:57]
    s_mov_b32 s56, 0x15554
    s_mov_b32 s57, 0x155540
    v_cndmask_b32 v110, v2, v3, s[56:57]
    s_mov_b32 s56, 0x2aaa8
    s_mov_b32 s57, 0x2aaa80
    v_cndmask_b32 v111, v2, v3, s[56:57]
    s_mov_b32 s56, 0x555500
    s_mov_b32 s57, 0x5555000
    v_cndmask_b32 v112, v2, v3, s[56:57]
    s_mov_b32 s56, 0xaaaa00
    s_mov_b32 s57, 0xaaaa000
    v_cndmask_b32 v113, v2, v3, s[56:57]
    s_mov_b32 s56, 0x1555400
    s_mov_b32 s57, 0x15554000
    v_cndmask_b32 v114, v2, v3, s[56:57]
    s_mov_b32 s56, 0x2aaa800
    s_mov_b32 s57, 0x2aaa8000
    v_cndmask_b32 v115, v2, v3, s[56:57]
    s_mov_b32 s56, 0x55550000
    s_mov_b32 s57, 0x55500000
    v_cndmask_b32 v116, v2, v3, s[56:57]
    s_mov_b32 s56, 0xaaaa0000
    s_mov_b32 s57, 0xaaa00000
    v_cndmask_b32 v117, v2, v3, s[56:57]
    s_mov_b32 s56, 0x55540000
    s_mov_b32 s57, 0x55400000
    v_cndmask_b32 v118, v2, v3, s[56:57]
    s_mov_b32 s56, 0xaaa80000
    s_mov_b32 s57, 0xaa800000
    v_cndmask_b32 v119, v2, v3, s[56:57]
    s_mov_b32 s56, 0x55000000
    s_mov_b32 s57, 0x50000000
    v_cndmask_b32 v120, v2, v3, s[56:57]
    s_mov_b32 s56, 0xaa000000
    s_mov_b32 s57, 0xa0000000
    v_cndmask_b32 v121, v2, v3, s[56:57]
    s_mov_b32 s56, 0x54000000
    s_mov_b32 s57, 0x40000000
    v_cndmask_b32 v122, v2, v3, s[56:57]
    s_mov_b32 s56, 0xa8000000
    s_mov_b32 s57, 0x80000000
    v_cndmask_b32 v123, v2, v3, s[56:57]
    s_mov_b32 s56, 0x0
    s_mov_b32 s57, 0x5
    s_and_b64 s[56:57], s[56:57], s[58:59]
    v_cndmask_b32 v124, v2, v3, s[56:57]
    s_mov_b32 s56, 0x0
    s_mov_b32 s57, 0xa
    s_and_b64 s[56:57], s[56:57], s[58:59]
    v_cndmask_b32 v125, v2, v3, s[56:57]
    s_mov_b32 s56, 0x1
    s_mov_b32 s57, 0x15
    s_and_b64 s[56:57], s[56:57], s[58:59]
    v_cndmask_b32 v126, v2, v3, s[56:57]
    s_mov_b32 s56, 0x2
    s_mov_b32 s57, 0x2a
    s_and_b64 s[56:57], s[56:57], s[58:59]
    v_cndmask_b32 v127, v2, v3, s[56:57]
    s_mov_b32 s56, 0x55
    s_mov_b32 s57, 0x555
    s_and_b64 s[56:57], s[56:57], s[58:59]
    v_cndmask_b32 v128, v2, v3, s[56:57]
    s_mov_b32 s56, 0xaa
    s_mov_b32 s57, 0xaaa
    s_and_b64 s[56:57], s[56:57], s[58:59]
    v_cndmask_b32 v129, v2, v3, s[56:57]
    s_mov_b32 s56, 0x155
    s_mov_b32 s57, 0x1555
    s_and_b64 s[56:57], s[56:57], s[58:59]
    v_cndmask_b32 v130, v2, v3, s[56:57]
    s_mov_b32 s56, 0x2aa
    s_mov_b32 s57, 0x2aaa
    s_and_b64 s[56:57], s[56:57], s[58:59]
    v_cndmask_b32 v131, v2, v3, s[56:57]
    s_mov_b32 s63, 0
TAG_L11:
    s_waitcnt vmcnt(0)
    v_readfirstlane_b32 s60, v24
    v_readfirstlane_b32 s61, v25
    s_nop 1
    s_cmp_lg_u32 s60, 0
    s_cbranch_scc1 TAG_OK11
    s_add_u32 s63, s63, 1
    s_cmp_gt_u32 s63, 131072
    s_cbranch_scc1 KERNEL_END
    global_load_dwordx2 v[24:25], v26, s[94:95] sc1
    s_branch TAG_L11
TAG_OK11:
    v_lshlrev_b32 v4, 4, v1
    s_and_b32 s3, s2, 7
    s_lshr_b32 s49, s2, 3
    s_mul_i32 s50, s49, 37
    s_lshr_b32 s50, s50, 8
    s_mul_i32 s51, s50, 7
    s_sub_u32 s51, s49, s51
    s_lshl_b32 s51, s51, 7
    s_lshl_b32 s3, s3, 2
    s_add_u32 s50, s50, s3
    s_and_b32 s50, s50, 31
    s_and_b32 s52, s23, 1
    s_lshl_b32 s3, s50, 1
    s_add_u32 s52, s52, s3
    s_lshr_b32 s53, s23, 1
    s_lshl_b32 s33, s22, 1
    s_add_u32 s33, s33, s20
    s_lshr_b32 s34, s33, 2
    s_sub_u32 s35, s26, 1
    s_max_i32 s35, s35, 0
    s_lshr_b32 s36, s35, 2
    s_lshl_b32 s34, s34, 4
    s_add_u32 s34, s34, 128
    s_add_u32 s40, s34, s21
    s_add_u32 s41, s34, s36
    s_add_u32 s42, s40, 64
    s_add_u32 s43, s41, 64
    s_lshl_b32 s44, s22, 4
    s_add_u32 s44, s44, s21
    s_add_u32 s44, s44, 384
    v_mov_b32 v136, s40
    v_writelane_b32 v136, s41, 1
    v_writelane_b32 v136, s42, 2
    v_writelane_b32 v136, s43, 3
    v_writelane_b32 v136, s44, 4
    v_lshlrev_b32 v136, 3, v136
    s_add_u32 s36, s33, 16
    s_lshl_b32 s36, s36, 6
    s_add_u32 s35, s35, s36
    s_add_u32 s36, s36, s26
    s_lshl_b32 s44, s36, 11
    s_lshl_b32 s45, s36, 12
    s_add_u32 s45, s45, 4194304
    s_lshl_b32 s46, s35, 12
    s_add_u32 s46, s46, 4194304
    s_add_u32 s47, s26, 64
    s_lshl_b32 s47, s47, 4
    s_add_u32 s47, s47, s33
    s_lshl_b32 s47, s47, 11
    s_add_u32 s47, s47, 12582912
    s_lshl_b32 s48, s21, 4
    s_add_u32 s48, s48, s33
    s_lshl_b32 s48, s48, 2
    s_add_u32 s48, s48, s62
    s_lshl_b32 s48, s48, 3
    s_add_u32 s48, s48, 16785408
    v_lshrrev_b32 v6, 3, v1
    v_mul_u32_u24 v3, 896, v6
    v_bfe_u32 v7, v1, 4, 1
    v_lshlrev_b32 v7, 2, v7
    v_and_b32 v6, 7, v1
    v_xor_b32 v7, v7, v6
    v_lshl_add_u32 v3, v7, 4, v3
    s_mul_i32 s54, s62, 7168
    s_add_u32 s54, s54, s51
    v_add_u32 v3, s54, v3
    s_lshl_b32 s55, s62, 10
    s_mov_b32 s12, s90
    s_and_b32 s13, s91, 0xffff
    s_mov_b32 s14, 401408
    s_mov_b32 s15, 0x20000
    s_mov_b32 s16, s84
    s_and_b32 s17, s85, 0xffff
    s_mov_b32 s18, 401408
    s_mov_b32 s19, 0x20000
    s_cmp_lg_u32 s62, 0
    s_cbranch_scc1 H_P0
    s_lshl_b32 s35, s33, 18
    s_add_u32 s35, s35, 4194304
    v_and_b32 v5, 31, v1
    v_lshlrev_b32 v5, 7, v5
    v_lshrrev_b32 v6, 5, v1
    v_lshl_add_u32 v5, v6, 16, v5
    s_add_u32 s36, s35, 0x20000
    s_lshr_b32 s34, s33, 2
    s_lshl_b32 s34, s34, 7
    v_and_b32 v134, 15, v1
    v_lshlrev_b32 v134, 3, v134
    v_bfe_u32 v6, v1, 4, 1
    v_lshl_add_u32 v134, v6, 9, v134
    v_add_u32 v134, s34, v134
    s_lshl_b32 s34, s22, 4
    s_add_u32 s34, s34, s21
    s_lshl_b32 s34, s34, 3
    s_add_u32 s34, s34, 2048
    s_cmp_eq_u32 s20, 0
    s_cselect_b32 exec_hi, 0, -1
    s_mov_b32 exec_lo, 0
    v_mov_b32 v134, s34
    s_mov_b64 exec, -1
    s_mov_b32 s34, 16777216
    s_lshl_b32 s40, s33, 6
    s_add_u32 s40, s40, s26
    s_lshl_b32 s40, s40, 11
    s_add_u32 s41, s40, 4096
    s_barrier
    buffer_load_dwordx2 v[132:133], v134, s[8:11], s34 offen sc1
    s_mov_b32 s63, 0
POLL12:
    s_waitcnt vmcnt(0)
    v_cmp_ne_u64 vcc, s[60:61], v[132:133]
    s_nop 1
    s_cbranch_vccz POLL_OK12
    s_add_u32 s63, s63, 1
    s_cmp_gt_u32 s63, 131072
    s_cbranch_scc1 KERNEL_END
    s_sleep 2
    buffer_load_dwordx2 v[132:133], v134, s[8:11], s34 offen sc1
    s_branch POLL12
POLL_OK12:
    buffer_load_dword v137, v5, s[8:11], s35 offen sc1
    buffer_load_dword v137, v5, s[8:11], s36 offen sc1
    s_cmp_eq_u32 s20, 0
    s_cbranch_scc1 H_W1
    s_mov_b32 m0, 151552
    s_nop 0
    buffer_load_dwordx4 v4, s[8:11], s40 offen offset:0 sc1 lds
    buffer_load_dwordx4 v4, s[8:11], s40 offen offset:1024 sc1 lds
    buffer_load_dwordx4 v4, s[8:11], s40 offen offset:2048 sc1 lds
    buffer_load_dwordx4 v4, s[8:11], s40 offen offset:3072 sc1 lds
    s_mov_b32 m0, 155648
    s_nop 0
    buffer_load_dwordx4 v4, s[8:11], s41 offen offset:0 sc1 lds
    buffer_load_dwordx4 v4, s[8:11], s41 offen offset:1024 sc1 lds
    buffer_load_dwordx4 v4, s[8:11], s41 offen offset:2048 sc1 lds
    buffer_load_dwordx4 v4, s[8:11], s41 offen offset:3072 sc1 lds
    s_waitcnt vmcnt(0)
    s_branch H_W1
H_P0:
    s_barrier
H_W1:
    s_barrier
    s_barrier
    s_mov_b32 s34, 16777216
    buffer_load_dwordx2 v[134:135], v136, s[8:11], s34 offen sc1
    s_mov_b32 s63, 0
POLL13:
    s_waitcnt vmcnt(0)
    v_cmp_ne_u64 vcc, s[60:61], v[134:135]
    s_nop 1
    s_cbranch_vccz POLL_OK13
    s_add_u32 s63, s63, 1
    s_cmp_gt_u32 s63, 131072
    s_cbranch_scc1 KERNEL_END
    s_sleep 8
    buffer_load_dwordx2 v[134:135], v136, s[8:11], s34 offen sc1
    s_branch POLL13
POLL_OK13:
    s_setprio 3
    buffer_load_dwordx4 v[16:19], v4, s[8:11], s44 offen offset:0 sc1
    buffer_load_dwordx4 v[20:23], v4, s[8:11], s44 offen offset:1024 sc1
    buffer_load_dwordx4 v[24:27], v4, s[8:11], s45 offen offset:0 sc1
    buffer_load_dwordx4 v[28:31], v4, s[8:11], s45 offen offset:1024 sc1
    buffer_load_dwordx4 v[40:43], v4, s[8:11], s46 offen offset:0 sc1
    buffer_load_dwordx4 v[44:47], v4, s[8:11], s46 offen offset:1024 sc1
    buffer_load_dwordx4 v[32:35], v4, s[8:11], s45 offen offset:2048 sc1
    buffer_load_dwordx4 v[36:39], v4, s[8:11], s45 offen offset:3072 sc1
    buffer_load_dwordx4 v[48:51], v4, s[8:11], s46 offen offset:3072 sc1
    s_waitcnt vmcnt(5)
    v_mfma_f32_32x32x16_bf16 v[64:79], v[24:27], v[16:19], v[108:123]
    v_mfma_f32_32x32x16_bf16 v[64:79], v[28:31], v[20:23], v[64:79]
    s_waitcnt vmcnt(3)
    v_mfma_f32_32x32x16_bf16 v[80:95], v[40:43], v[16:19], v[116:131]
    v_mfma_f32_32x32x16_bf16 v[80:95], v[44:47], v[20:23], v[80:95]
    s_waitcnt vmcnt(0)
    s_nop 7
    v_max3_f32 v8, v64, v65, v66
    v_max3_f32 v8, v8, v67, v68
    v_max3_f32 v8, v8, v69, v70
    v_max3_f32 v8, v8, v71, v72
    v_max3_f32 v8, v8, v73, v74
    v_max3_f32 v8, v8, v75, v76
    v_max3_f32 v8, v8, v77, v78
    v_max_f32 v8, v8, v79
    v_max3_f32 v8, v8, v88, v89
    v_max3_f32 v8, v8, v90, v91
    v_max3_f32 v8, v8, v92, v93
    v_max3_f32 v8, v8, v94, v95
    v_mov_b32 v9, v8
    s_nop 1
    v_permlane32_swap_b32 v8, v9
    v_max_f32 v8, v8, v9
    v_pk_add_f32 v[64:65], v[64:65], v[8:9] op_sel_hi:[1,0] neg_lo:[0,1] neg_hi:[0,1]
    v_pk_add_f32 v[66:67], v[66:67], v[8:9] op_sel_hi:[1,0] neg_lo:[0,1] neg_hi:[0,1]
    v_pk_add_f32 v[68:69], v[68:69], v[8:9] op_sel_hi:[1,0] neg_lo:[0,1] neg_hi:[0,1]
    v_pk_add_f32 v[70:71], v[70:71], v[8:9] op_sel_hi:[1,0] neg_lo:[0,1] neg_hi:[0,1]
    v_pk_add_f32 v[72:73], v[72:73], v[8:9] op_sel_hi:[1,0] neg_lo:[0,1] neg_hi:[0,1]
    v_pk_add_f32 v[74:75], v[74:75], v[8:9] op_sel_hi:[1,0] neg_lo:[0,1] neg_hi:[0,1]
    v_pk_add_f32 v[76:77], v[76:77], v[8:9] op_sel_hi:[1,0] neg_lo:[0,1] neg_hi:[0,1]
    v_pk_add_f32 v[78:79], v[78:79], v[8:9] op_sel_hi:[1,0] neg_lo:[0,1] neg_hi:[0,1]
    v_pk_add_f32 v[88:89], v[88:89], v[8:9] op_sel_hi:[1,0] neg_lo:[0,1] neg_hi:[0,1]
    v_pk_add_f32 v[90:91], v[90:91], v[8:9] op_sel_hi:[1,0] neg_lo:[0,1] neg_hi:[0,1]
    v_pk_add_f32 v[92:93], v[92:93], v[8:9] op_sel_hi:[1,0] neg_lo:[0,1] neg_hi:[0,1]
    v_pk_add_f32 v[94:95], v[94:95], v[8:9] op_sel_hi:[1,0] neg_lo:[0,1] neg_hi:[0,1]
    v_exp_f32 v64, v64
    v_exp_f32 v65, v65
    v_exp_f32 v66, v66
    v_exp_f32 v67, v67
    v_exp_f32 v68, v68
    v_exp_f32 v69, v69
    v_exp_f32 v70, v70
    v_exp_f32 v71, v71
    v_exp_f32 v72, v72
    v_exp_f32 v73, v73
    v_exp_f32 v74, v74
    v_exp_f32 v75, v75
    v_exp_f32 v76, v76
    v_exp_f32 v77, v77
    v_exp_f32 v78, v78
    v_exp_f32 v79, v79
    v_exp_f32 v88, v88
    v_exp_f32 v89, v89
    v_exp_f32 v90, v90
    v_exp_f32 v91, v91
    v_exp_f32 v92, v92
    v_exp_f32 v93, v93
    v_exp_f32 v94, v94
    v_exp_f32 v95, v95
    s_setprio 3
    v_cvt_pk_bf16_f32 v96, v64, v65
    v_cvt_pk_bf16_f32 v97, v66, v67
    v_cvt_pk_bf16_f32 v98, v68, v69
    v_cvt_pk_bf16_f32 v99, v70, v71
    v_cvt_pk_bf16_f32 v100, v72, v73
    v_cvt_pk_bf16_f32 v101, v74, v75
    v_cvt_pk_bf16_f32 v102, v76, v77
    v_cvt_pk_bf16_f32 v103, v78, v79
    v_cvt_pk_bf16_f32 v104, v88, v89
    v_cvt_pk_bf16_f32 v105, v90, v91
    v_cvt_pk_bf16_f32 v106, v92, v93
    v_cvt_pk_bf16_f32 v107, v94, v95
    v_mfma_f32_32x32x16_bf16 v[16:31], v[32:35], v[96:99], 0
    v_mfma_f32_32x32x16_bf16 v[16:31], v[36:39], v[100:103], v[16:31]
    v_mfma_f32_32x32x16_bf16 v[16:31], v[48:51], v[104:107], v[16:31]
    s_nop 11
    v_mov_b32 v8, v28
    v_mov_b32 v10, v28
    s_nop 1
    v_permlane32_swap_b32 v8, v10
    v_rcp_f32 v10, v10
    s_nop 0
    v_pk_mul_f32 v[16:17], v[16:17], v[10:11] op_sel_hi:[1,0]
    v_pk_mul_f32 v[18:19], v[18:19], v[10:11] op_sel_hi:[1,0]
    v_pk_mul_f32 v[20:21], v[20:21], v[10:11] op_sel_hi:[1,0]
    v_pk_mul_f32 v[22:23], v[22:23], v[10:11] op_sel_hi:[1,0]
    v_pk_mul_f32 v[24:25], v[24:25], v[10:11] op_sel_hi:[1,0]
    v_pk_mul_f32 v[26:27], v[26:27], v[10:11] op_sel_hi:[1,0]
    v_pk_mul_f32 v[28:29], v[28:29], v[10:11] op_sel_hi:[1,0]
    v_pk_mul_f32 v[30:31], v[30:31], v[10:11] op_sel_hi:[1,0]
    v_cvt_pk_bf16_f32 v16, v16, v17
    v_cvt_pk_bf16_f32 v17, v18, v19
    v_cvt_pk_bf16_f32 v18, v20, v21
    v_cvt_pk_bf16_f32 v19, v22, v23
    v_cvt_pk_bf16_f32 v20, v24, v25
    v_cvt_pk_bf16_f32 v21, v26, v27
    v_cvt_pk_bf16_f32 v22, v28, v29
    v_cvt_pk_bf16_f32 v23, v30, v31
    s_mov_b32 exec_lo, 0
    s_mov_b32 exec_hi, -1
    v_mov_b32 v22, 0
    v_mov_b32 v23, 0
    s_mov_b64 exec, -1
    buffer_store_dwordx4 v[16:19], v4, s[8:11], s47 offen offset:0 sc0 sc1
    buffer_store_dwordx4 v[20:23], v4, s[8:11], s47 offen offset:1024 sc0 sc1
    s_setprio 0
    s_waitcnt vmcnt(0)
    v_mov_b32 v134, s60
    v_mov_b32 v135, s61
    v_lshlrev_b32 v136, 3, v1
    s_mov_b32 exec_lo, 1
    s_mov_b32 exec_hi, 0
    buffer_store_dwordx2 v[134:135], v136, s[8:11], s48 offen sc1
    s_mov_b64 exec, -1
    s_setprio 0
    s_cmp_ge_u32 s2, 224
    s_cbranch_scc1 H_NOP3
    s_cmp_ge_u32 s2, 224
    s_cbranch_scc1 WO_SKIP0
    s_mov_b32 s54, 0
    s_add_u32 m0, s55, 0
    s_nop 0
    buffer_load_dwordx4 v3, s[12:15], s54 offen lds
    s_add_u32 m0, s55, 57344
    s_nop 0
    buffer_load_dwordx4 v3, s[16:19], s54 offen lds
    s_mov_b32 s54, 28672
    s_add_u32 m0, s55, 4096
    s_nop 0
    buffer_load_dwordx4 v3, s[12:15], s54 offen lds
    s_add_u32 m0, s55, 61440
    s_nop 0
    buffer_load_dwordx4 v3, s[16:19], s54 offen lds
WO_SKIP0:
    s_waitcnt vmcnt(0)
    s_cmp_ge_u32 s2, 224
    s_cbranch_scc1 WO_SKIP1
    s_mov_b32 s54, 57344
    s_add_u32 m0, s55, 8192
    s_nop 0
    buffer_load_dwordx4 v3, s[12:15], s54 offen lds
    s_add_u32 m0, s55, 65536
    s_nop 0
    buffer_load_dwordx4 v3, s[16:19], s54 offen lds
    s_mov_b32 s54, 86016
    s_add_u32 m0, s55, 12288
    s_nop 0
    buffer_load_dwordx4 v3, s[12:15], s54 offen lds
    s_add_u32 m0, s55, 69632
    s_nop 0
    buffer_load_dwordx4 v3, s[16:19], s54 offen lds
WO_SKIP1:
    s_waitcnt vmcnt(0)
    s_cmp_ge_u32 s2, 224
    s_cbranch_scc1 WO_SKIP2
    s_mov_b32 s54, 114688
    s_add_u32 m0, s55, 16384
    s_nop 0
    buffer_load_dwordx4 v3, s[12:15], s54 offen lds
    s_add_u32 m0, s55, 73728
    s_nop 0
    buffer_load_dwordx4 v3, s[16:19], s54 offen lds
    s_mov_b32 s54, 143360
    s_add_u32 m0, s55, 20480
    s_nop 0
    buffer_load_dwordx4 v3, s[12:15], s54 offen lds
    s_add_u32 m0, s55, 77824
    s_nop 0
    buffer_load_dwordx4 v3, s[16:19], s54 offen lds
WO_SKIP2:
    s_waitcnt vmcnt(0)
    s_cmp_ge_u32 s2, 224
    s_cbranch_scc1 WO_SKIP3
    s_mov_b32 s54, 172032
    s_add_u32 m0, s55, 24576
    s_nop 0
    buffer_load_dwordx4 v3, s[12:15], s54 offen lds
    s_add_u32 m0, s55, 81920
    s_nop 0
    buffer_load_dwordx4 v3, s[16:19], s54 offen lds
    s_mov_b32 s54, 200704
    s_add_u32 m0, s55, 28672
    s_nop 0
    buffer_load_dwordx4 v3, s[12:15], s54 offen lds
    s_add_u32 m0, s55, 86016
    s_nop 0
    buffer_load_dwordx4 v3, s[16:19], s54 offen lds
WO_SKIP3:
    s_waitcnt vmcnt(0)
    s_cmp_ge_u32 s2, 224
    s_cbranch_scc1 WO_SKIP4
    s_mov_b32 s54, 229376
    s_add_u32 m0, s55, 32768
    s_nop 0
    buffer_load_dwordx4 v3, s[12:15], s54 offen lds
    s_add_u32 m0, s55, 90112
    s_nop 0
    buffer_load_dwordx4 v3, s[16:19], s54 offen lds
    s_mov_b32 s54, 258048
    s_add_u32 m0, s55, 36864
    s_nop 0
    buffer_load_dwordx4 v3, s[12:15], s54 offen lds
    s_add_u32 m0, s55, 94208
    s_nop 0
    buffer_load_dwordx4 v3, s[16:19], s54 offen lds
WO_SKIP4:
    s_waitcnt vmcnt(0)
    s_cmp_ge_u32 s2, 224
    s_cbranch_scc1 WO_SKIP5
    s_mov_b32 s54, 286720
    s_add_u32 m0, s55, 40960
    s_nop 0
    buffer_load_dwordx4 v3, s[12:15], s54 offen lds
    s_add_u32 m0, s55, 98304
    s_nop 0
    buffer_load_dwordx4 v3, s[16:19], s54 offen lds
    s_mov_b32 s54, 315392
    s_add_u32 m0, s55, 45056
    s_nop 0
    buffer_load_dwordx4 v3, s[12:15], s54 offen lds
    s_add_u32 m0, s55, 102400
    s_nop 0
    buffer_load_dwordx4 v3, s[16:19], s54 offen lds
WO_SKIP5:
    s_waitcnt vmcnt(0)
    s_cmp_ge_u32 s2, 224
    s_cbranch_scc1 WO_SKIP6
    s_mov_b32 s54, 344064
    s_add_u32 m0, s55, 49152
    s_nop 0
    buffer_load_dwordx4 v3, s[12:15], s54 offen lds
    s_add_u32 m0, s55, 106496
    s_nop 0
    buffer_load_dwordx4 v3, s[16:19], s54 offen lds
    s_mov_b32 s54, 372736
    s_add_u32 m0, s55, 53248
    s_nop 0
    buffer_load_dwordx4 v3, s[12:15], s54 offen lds
    s_add_u32 m0, s55, 110592
    s_nop 0
    buffer_load_dwordx4 v3, s[16:19], s54 offen lds
WO_SKIP6:
    s_waitcnt vmcnt(0)
    v_bfe_u32 v6, v1, 2, 2
    v_lshrrev_b32 v7, 5, v1
    v_lshl_add_u32 v8, v7, 2, v6
    v_lshlrev_b32 v5, 7, v8
    s_and_b32 s54, s53, 1
    s_lshr_b32 s55, s53, 1
    v_bfe_u32 v8, v1, 4, 1
    v_xor_b32 v8, s54, v8
    v_lshl_add_u32 v5, v8, 5, v5
    v_and_b32 v8, 1, v1
    v_lshl_add_u32 v5, v8, 4, v5
    v_bfe_u32 v8, v1, 1, 1
    v_lshl_add_u32 v5, v8, 3, v5
    s_mul_i32 s56, s53, 14336
    v_add_u32 v5, s56, v5
    v_lshrrev_b32 v6, 1, v6
    v_xor_b32 v6, s55, v6
    v_lshl_add_u32 v131, v6, 6, v5
    v_xor_b32 v6, 1, v6
    v_lshl_add_u32 v132, v6, 6, v5
    v_lshlrev_b32 v9, 9, v7
    v_sub_u32 v133, v131, v9
    v_sub_u32 v134, v132, v9
    s_and_b32 s56, s23, 1
    s_mul_i32 s56, s56, 24576
    s_add_u32 s56, s56, 114688
    s_xor_b32 s57, s53, 1
    s_mul_i32 s57, s57, 6144
    s_add_u32 s57, s57, s56
    s_add_u32 s57, s57, 0
    v_add_u32 v135, s57, v4
    s_xor_b32 s57, s53, 2
    s_mul_i32 s57, s57, 6144
    s_add_u32 s57, s57, s56
    s_add_u32 s57, s57, 2048
    v_add_u32 v136, s57, v4
    s_xor_b32 s57, s53, 3
    s_mul_i32 s57, s57, 6144
    s_add_u32 s57, s57, s56
    s_add_u32 s57, s57, 4096
    v_add_u32 v137, s57, v4
    s_mul_i32 s57, s53, 6144
    s_add_u32 s57, s57, s56
    v_add_u32 v138, s57, v4
    v_and_b32 v8, 31, v1
    v_mul_u32_u24 v8, 1792, v8
    v_lshl_add_u32 v139, v7, 4, v8
    s_mul_i32 s58, s52, 57344
    s_add_u32 s58, s58, s51
    s_lshl_b32 s57, s53, 5
    s_add_u32 s58, s58, s57
    s_add_u32 s59, s58, 896
    s_mov_b32 s16, s92
    s_and_b32 s17, s93, 0xffff
    s_mov_b32 s18, 3670016
    s_mov_b32 s19, 0x20000
    s_add_u32 s29, s52, 64
    s_lshl_b32 s29, s29, 4
    s_lshl_b32 s28, s53, 2
    s_add_u32 s29, s29, s28
    s_lshl_b32 s29, s29, 11
    s_add_u32 s29, s29, 12582912
    s_add_u32 s30, s29, 4096
    s_waitcnt vmcnt(0)
    s_cmp_lg_u32 s62, 0
    s_cbranch_scc1 H_C1
    s_lshr_b32 s34, s50, 1
    s_lshl_b32 s34, s34, 9
    s_add_u32 s34, s34, 16785408
    v_and_b32 v130, 63, v1
    v_lshlrev_b32 v130, 3, v130
    buffer_load_dwordx2 v[128:129], v130, s[8:11], s34 offen sc1
    s_mov_b32 s63, 0
POLL14:
    s_waitcnt vmcnt(0)
    v_cmp_ne_u64 vcc, s[60:61], v[128:129]
    s_nop 1
    s_cbranch_vccz POLL_OK14
    s_add_u32 s63, s63, 1
    s_cmp_gt_u32 s63, 131072
    s_cbranch_scc1 KERNEL_END
    s_sleep 8
    buffer_load_dwordx2 v[128:129], v130, s[8:11], s34 offen sc1
    s_branch POLL14
POLL_OK14:
H_C1:
    v_mov_b32 v5, 0x7f000000
    s_barrier
    buffer_load_dwordx4 a[0:3], v4, s[8:11], s29 offen offset:0 sc1
    buffer_load_dwordx4 a[4:7], v4, s[8:11], s29 offen offset:1024 sc1
    buffer_load_dwordx4 a[8:11], v4, s[8:11], s29 offen offset:2048 sc1
    buffer_load_dwordx4 a[12:15], v4, s[8:11], s29 offen offset:3072 sc1
    buffer_load_dwordx4 a[16:19], v4, s[8:11], s30 offen offset:0 sc1
    buffer_load_dwordx4 a[20:23], v4, s[8:11], s30 offen offset:1024 sc1
    buffer_load_dwordx4 a[24:27], v4, s[8:11], s30 offen offset:2048 sc1
    buffer_load_dwordx4 a[28:31], v4, s[8:11], s30 offen offset:3072 sc1
    s_barrier
    s_barrier
    s_branch P3B
H_NOP3:
    s_barrier
    s_barrier
    s_barrier
    s_branch KF_FIN
P1V:
    s_barrier
    s_cmp_lg_u32 s62, 3
    s_cbranch_scc1 PF_SKIP15
    s_mov_b32 s3, 688128
    s_mov_b32 exec_hi, 0
    buffer_load_dword v143, v140, s[12:15], 0 offen offset:512
    s_mov_b32 exec_lo, 0x3fffff
    buffer_load_dword v143, v141, s[16:19], s3 offen
    s_mov_b64 exec, -1
PF_SKIP15:
    s_cmp_lg_u32 s62, 0
    s_cbranch_scc1 PF_SKIP16
    s_mov_b32 s3, 860160
    s_mov_b32 exec_hi, 0
    buffer_load_dword v143, v140, s[12:15], 0 offen offset:640
    s_mov_b32 exec_lo, 0x3fffff
    buffer_load_dword v143, v141, s[16:19], s3 offen
    s_mov_b64 exec, -1
PF_SKIP16:
    s_cmp_lg_u32 s62, 1
    s_cbranch_scc1 PF_SKIP17
    s_mov_b32 s3, 1032192
    s_mov_b32 exec_hi, 0
    buffer_load_dword v143, v140, s[12:15], 0 offen offset:768
    s_mov_b32 exec_lo, 0x3fffff
    buffer_load_dword v143, v141, s[16:19], s3 offen
    s_mov_b64 exec, -1
PF_SKIP17:
    ds_read_b128 a[0:3], v4 offset:0
    ds_read_b64_tr_b16 v[80:81], v124 offset:0
    ds_read_b64_tr_b16 v[82:83], v124 offset:1024
    ds_read_b64_tr_b16 v[84:85], v125 offset:0
    ds_read_b64_tr_b16 v[86:87], v125 offset:1024
    ds_read_b64_tr_b16 v[88:89], v126 offset:0
    ds_read_b64_tr_b16 v[90:91], v126 offset:1024
    ds_read_b64_tr_b16 v[92:93], v127 offset:0
    ds_read_b64_tr_b16 v[94:95], v127 offset:1024
    ds_read_b128 a[4:7], v5 offset:0
    ds_read_b64_tr_b16 v[96:97], v124 offset:4096
    ds_read_b64_tr_b16 v[98:99], v124 offset:5120
    ds_read_b64_tr_b16 v[100:101], v125 offset:4096
    ds_read_b64_tr_b16 v[102:103], v125 offset:5120
    ds_read_b64_tr_b16 v[104:105], v126 offset:4096
    ds_read_b64_tr_b16 v[106:107], v126 offset:5120
    ds_read_b64_tr_b16 v[108:109], v127 offset:4096
    ds_read_b64_tr_b16 v[110:111], v127 offset:5120
    s_waitcnt lgkmcnt(15)
    v_mfma_f32_32x32x16_bf16 v[16:31], a[0:3], v[80:83], 0
    ds_read_b128 a[8:11], v6 offset:0
    ds_read_b64_tr_b16 v[112:113], v124 offset:8192
    ds_read_b64_tr_b16 v[114:115], v124 offset:9216
    s_waitcnt lgkmcnt(15)
    v_mfma_f32_32x32x16_bf16 v[32:47], a[0:3], v[84:87], 0
    ds_read_b64_tr_b16 v[116:117], v125 offset:8192
    ds_read_b64_tr_b16 v[118:119], v125 offset:9216
    s_waitcnt lgkmcnt(15)
    v_mfma_f32_32x32x16_bf16 v[48:63], a[0:3], v[88:91], 0
    ds_read_b64_tr_b16 v[120:121], v126 offset:8192
    ds_read_b64_tr_b16 v[122:123], v126 offset:9216
    s_waitcnt lgkmcnt(15)
    v_mfma_f32_32x32x16_bf16 v[64:79], a[0:3], v[92:95], 0
    ds_read_b64_tr_b16 v[80:81], v127 offset:8192
    ds_read_b64_tr_b16 v[82:83], v127 offset:9216
    s_waitcnt lgkmcnt(15)
    v_mfma_f32_32x32x16_bf16 v[16:31], a[4:7], v[96:99], v[16:31]
    ds_read_b128 a[12:15], v7 offset:0
    ds_read_b64_tr_b16 v[84:85], v124 offset:12288
    ds_read_b64_tr_b16 v[86:87], v124 offset:13312
    s_waitcnt lgkmcnt(15)
    v_mfma_f32_32x32x16_bf16 v[32:47], a[4:7], v[100:103], v[32:47]
    ds_read_b64_tr_b16 v[88:89], v125 offset:12288
    ds_read_b64_tr_b16 v[90:91], v125 offset:13312
    s_waitcnt lgkmcnt(15)
    v_mfma_f32_32x32x16_bf16 v[48:63], a[4:7], v[104:107], v[48:63]
    ds_read_b64_tr_b16 v[92:93], v126 offset:12288
    ds_read_b64_tr_b16 v[94:95], v126 offset:13312
    s_waitcnt lgkmcnt(15)
    v_mfma_f32_32x32x16_bf16 v[64:79], a[4:7], v[108:111], v[64:79]
    ds_read_b64_tr_b16 v[96:97], v127 offset:12288
    ds_read_b64_tr_b16 v[98:99], v127 offset:13312
    s_waitcnt lgkmcnt(15)
    v_mfma_f32_32x32x16_bf16 v[16:31], a[8:11], v[112:115], v[16:31]
    s_barrier
    ds_read_b128 a[16:19], v4 offset:32768
    ds_read_b64_tr_b16 v[100:101], v124 offset:32768
    ds_read_b64_tr_b16 v[102:103], v124 offset:33792
    s_waitcnt lgkmcnt(15)
    v_mfma_f32_32x32x16_bf16 v[32:47], a[8:11], v[116:119], v[32:47]
    ds_read_b64_tr_b16 v[104:105], v125 offset:32768
    ds_read_b64_tr_b16 v[106:107], v125 offset:33792
    s_waitcnt lgkmcnt(15)
    v_mfma_f32_32x32x16_bf16 v[48:63], a[8:11], v[120:123], v[48:63]
    ds_read_b64_tr_b16 v[108:109], v126 offset:32768
    ds_read_b64_tr_b16 v[110:111], v126 offset:33792
    s_waitcnt lgkmcnt(15)
    v_mfma_f32_32x32x16_bf16 v[64:79], a[8:11], v[80:83], v[64:79]
    ds_read_b64_tr_b16 v[112:113], v127 offset:32768
    ds_read_b64_tr_b16 v[114:115], v127 offset:33792
    s_waitcnt lgkmcnt(15)
    v_mfma_f32_32x32x16_bf16 v[16:31], a[12:15], v[84:87], v[16:31]
    ds_read_b128 a[20:23], v5 offset:32768
    ds_read_b64_tr_b16 v[116:117], v124 offset:36864
    ds_read_b64_tr_b16 v[118:119], v124 offset:37888
    s_waitcnt lgkmcnt(15)
    v_mfma_f32_32x32x16_bf16 v[32:47], a[12:15], v[88:91], v[32:47]
    ds_read_b64_tr_b16 v[120:121], v125 offset:36864
    ds_read_b64_tr_b16 v[122:123], v125 offset:37888
    s_waitcnt lgkmcnt(15)
    v_mfma_f32_32x32x16_bf16 v[48:63], a[12:15], v[92:95], v[48:63]
    ds_read_b64_tr_b16 v[80:81], v126 offset:36864
    ds_read_b64_tr_b16 v[82:83], v126 offset:37888
    s_waitcnt lgkmcnt(15)
    v_mfma_f32_32x32x16_bf16 v[64:79], a[12:15], v[96:99], v[64:79]
    ds_read_b64_tr_b16 v[84:85], v127 offset:36864
    ds_read_b64_tr_b16 v[86:87], v127 offset:37888
    s_waitcnt lgkmcnt(15)
    v_mfma_f32_32x32x16_bf16 v[16:31], a[16:19], v[100:103], v[16:31]
    ds_read_b128 a[24:27], v6 offset:32768
    ds_read_b64_tr_b16 v[88:89], v124 offset:40960
    ds_read_b64_tr_b16 v[90:91], v124 offset:41984
    s_waitcnt lgkmcnt(15)
    v_mfma_f32_32x32x16_bf16 v[32:47], a[16:19], v[104:107], v[32:47]
    ds_read_b64_tr_b16 v[92:93], v125 offset:40960
    ds_read_b64_tr_b16 v[94:95], v125 offset:41984
    s_waitcnt lgkmcnt(15)
    v_mfma_f32_32x32x16_bf16 v[48:63], a[16:19], v[108:111], v[48:63]
    ds_read_b64_tr_b16 v[96:97], v126 offset:40960
    ds_read_b64_tr_b16 v[98:99], v126 offset:41984
    s_waitcnt lgkmcnt(15)
    v_mfma_f32_32x32x16_bf16 v[64:79], a[16:19], v[112:115], v[64:79]
    ds_read_b64_tr_b16 v[100:101], v127 offset:40960
    ds_read_b64_tr_b16 v[102:103], v127 offset:41984
    s_waitcnt lgkmcnt(15)
    v_mfma_f32_32x32x16_bf16 v[16:31], a[20:23], v[116:119], v[16:31]
    ds_read_b128 a[28:31], v7 offset:32768
    ds_read_b64_tr_b16 v[104:105], v124 offset:45056
    ds_read_b64_tr_b16 v[106:107], v124 offset:46080
    s_waitcnt lgkmcnt(15)
    v_mfma_f32_32x32x16_bf16 v[32:47], a[20:23], v[120:123], v[32:47]
    ds_read_b64_tr_b16 v[108:109], v125 offset:45056
    ds_read_b64_tr_b16 v[110:111], v125 offset:46080
    s_waitcnt lgkmcnt(15)
    v_mfma_f32_32x32x16_bf16 v[48:63], a[20:23], v[80:83], v[48:63]
    ds_read_b64_tr_b16 v[112:113], v126 offset:45056
    ds_read_b64_tr_b16 v[114:115], v126 offset:46080
    s_waitcnt lgkmcnt(15)
    v_mfma_f32_32x32x16_bf16 v[64:79], a[20:23], v[84:87], v[64:79]
    ds_read_b64_tr_b16 v[116:117], v127 offset:45056
    ds_read_b64_tr_b16 v[118:119], v127 offset:46080
    s_waitcnt lgkmcnt(15)
    v_mfma_f32_32x32x16_bf16 v[16:31], a[24:27], v[88:91], v[16:31]
    s_barrier
    ds_read_b128 a[32:35], v8 offset:0
    ds_read_b64_tr_b16 v[120:121], v128 offset:0
    ds_read_b64_tr_b16 v[122:123], v128 offset:1024
    s_waitcnt lgkmcnt(15)
    v_mfma_f32_32x32x16_bf16 v[32:47], a[24:27], v[92:95], v[32:47]
    ds_read_b64_tr_b16 v[80:81], v129 offset:0
    ds_read_b64_tr_b16 v[82:83], v129 offset:1024
    s_waitcnt lgkmcnt(15)
    v_mfma_f32_32x32x16_bf16 v[48:63], a[24:27], v[96:99], v[48:63]
    ds_read_b64_tr_b16 v[84:85], v130 offset:0
    ds_read_b64_tr_b16 v[86:87], v130 offset:1024
    s_waitcnt lgkmcnt(15)
    v_mfma_f32_32x32x16_bf16 v[64:79], a[24:27], v[100:103], v[64:79]
    ds_read_b64_tr_b16 v[88:89], v131 offset:0
    ds_read_b64_tr_b16 v[90:91], v131 offset:1024
    s_waitcnt lgkmcnt(15)
    v_mfma_f32_32x32x16_bf16 v[16:31], a[28:31], v[104:107], v[16:31]
    ds_read_b128 a[36:39], v9 offset:0
    ds_read_b64_tr_b16 v[92:93], v128 offset:4096
    ds_read_b64_tr_b16 v[94:95], v128 offset:5120
    s_waitcnt lgkmcnt(15)
    v_mfma_f32_32x32x16_bf16 v[32:47], a[28:31], v[108:111], v[32:47]
    ds_read_b64_tr_b16 v[96:97], v129 offset:4096
    ds_read_b64_tr_b16 v[98:99], v129 offset:5120
    s_waitcnt lgkmcnt(15)
    v_mfma_f32_32x32x16_bf16 v[48:63], a[28:31], v[112:115], v[48:63]
    ds_read_b64_tr_b16 v[100:101], v130 offset:4096
    ds_read_b64_tr_b16 v[102:103], v130 offset:5120
    s_waitcnt lgkmcnt(15)
    v_mfma_f32_32x32x16_bf16 v[64:79], a[28:31], v[116:119], v[64:79]
    ds_read_b64_tr_b16 v[104:105], v131 offset:4096
    ds_read_b64_tr_b16 v[106:107], v131 offset:5120
    s_waitcnt lgkmcnt(15)
    v_mfma_f32_32x32x16_bf16 v[16:31], a[32:35], v[120:123], v[16:31]
    ds_read_b128 a[40:43], v10 offset:0
    ds_read_b64_tr_b16 v[108:109], v128 offset:8192
    ds_read_b64_tr_b16 v[110:111], v128 offset:9216
    s_waitcnt lgkmcnt(15)
    v_mfma_f32_32x32x16_bf16 v[32:47], a[32:35], v[80:83], v[32:47]
    ds_read_b64_tr_b16 v[112:113], v129 offset:8192
    ds_read_b64_tr_b16 v[114:115], v129 offset:9216
    s_waitcnt lgkmcnt(15)
    v_mfma_f32_32x32x16_bf16 v[48:63], a[32:35], v[84:87], v[48:63]
    ds_read_b64_tr_b16 v[116:117], v130 offset:8192
    ds_read_b64_tr_b16 v[118:119], v130 offset:9216
    s_waitcnt lgkmcnt(15)
    v_mfma_f32_32x32x16_bf16 v[64:79], a[32:35], v[88:91], v[64:79]
    ds_read_b64_tr_b16 v[120:121], v131 offset:8192
    ds_read_b64_tr_b16 v[122:123], v131 offset:9216
    s_waitcnt lgkmcnt(15)
    v_mfma_f32_32x32x16_bf16 v[16:31], a[36:39], v[92:95], v[16:31]
    ds_read_b128 a[44:47], v11 offset:0
    ds_read_b64_tr_b16 v[80:81], v128 offset:12288
    ds_read_b64_tr_b16 v[82:83], v128 offset:13312
    s_waitcnt lgkmcnt(15)
    v_mfma_f32_32x32x16_bf16 v[32:47], a[36:39], v[96:99], v[32:47]
    ds_read_b64_tr_b16 v[84:85], v129 offset:12288
    ds_read_b64_tr_b16 v[86:87], v129 offset:13312
    s_waitcnt lgkmcnt(15)
    v_mfma_f32_32x32x16_bf16 v[48:63], a[36:39], v[100:103], v[48:63]
    ds_read_b64_tr_b16 v[88:89], v130 offset:12288
    ds_read_b64_tr_b16 v[90:91], v130 offset:13312
    s_waitcnt lgkmcnt(15)
    v_mfma_f32_32x32x16_bf16 v[64:79], a[36:39], v[104:107], v[64:79]
    ds_read_b64_tr_b16 v[92:93], v131 offset:12288
    ds_read_b64_tr_b16 v[94:95], v131 offset:13312
    s_waitcnt lgkmcnt(15)
    v_mfma_f32_32x32x16_bf16 v[16:31], a[40:43], v[108:111], v[16:31]
    s_barrier
    ds_read_b128 a[48:51], v8 offset:32768
    ds_read_b64_tr_b16 v[96:97], v128 offset:32768
    ds_read_b64_tr_b16 v[98:99], v128 offset:33792
    s_waitcnt lgkmcnt(15)
    v_mfma_f32_32x32x16_bf16 v[32:47], a[40:43], v[112:115], v[32:47]
    ds_read_b64_tr_b16 v[100:101], v129 offset:32768
    ds_read_b64_tr_b16 v[102:103], v129 offset:33792
    s_waitcnt lgkmcnt(15)
    v_mfma_f32_32x32x16_bf16 v[48:63], a[40:43], v[116:119], v[48:63]
    ds_read_b64_tr_b16 v[104:105], v130 offset:32768
    ds_read_b64_tr_b16 v[106:107], v130 offset:33792
    s_waitcnt lgkmcnt(15)
    v_mfma_f32_32x32x16_bf16 v[64:79], a[40:43], v[120:123], v[64:79]
    ds_read_b64_tr_b16 v[108:109], v131 offset:32768
    ds_read_b64_tr_b16 v[110:111], v131 offset:33792
    s_waitcnt lgkmcnt(15)
    v_mfma_f32_32x32x16_bf16 v[16:31], a[44:47], v[80:83], v[16:31]
    ds_read_b128 a[52:55], v9 offset:32768
    ds_read_b64_tr_b16 v[112:113], v128 offset:36864
    ds_read_b64_tr_b16 v[114:115], v128 offset:37888
    s_waitcnt lgkmcnt(15)
    v_mfma_f32_32x32x16_bf16 v[32:47], a[44:47], v[84:87], v[32:47]
    ds_read_b64_tr_b16 v[116:117], v129 offset:36864
    ds_read_b64_tr_b16 v[118:119], v129 offset:37888
    s_waitcnt lgkmcnt(15)
    v_mfma_f32_32x32x16_bf16 v[48:63], a[44:47], v[88:91], v[48:63]
    ds_read_b64_tr_b16 v[120:121], v130 offset:36864
    ds_read_b64_tr_b16 v[122:123], v130 offset:37888
    s_waitcnt lgkmcnt(15)
    v_mfma_f32_32x32x16_bf16 v[64:79], a[44:47], v[92:95], v[64:79]
    ds_read_b64_tr_b16 v[80:81], v131 offset:36864
    ds_read_b64_tr_b16 v[82:83], v131 offset:37888
    s_waitcnt lgkmcnt(15)
    v_mfma_f32_32x32x16_bf16 v[16:31], a[48:51], v[96:99], v[16:31]
    ds_read_b128 a[56:59], v10 offset:32768
    ds_read_b64_tr_b16 v[84:85], v128 offset:40960
    ds_read_b64_tr_b16 v[86:87], v128 offset:41984
    s_waitcnt lgkmcnt(15)
    v_mfma_f32_32x32x16_bf16 v[32:47], a[48:51], v[100:103], v[32:47]
    ds_read_b64_tr_b16 v[88:89], v129 offset:40960
    ds_read_b64_tr_b16 v[90:91], v129 offset:41984
    s_waitcnt lgkmcnt(15)
    v_mfma_f32_32x32x16_bf16 v[48:63], a[48:51], v[104:107], v[48:63]
    ds_read_b64_tr_b16 v[92:93], v130 offset:40960
    ds_read_b64_tr_b16 v[94:95], v130 offset:41984
    s_waitcnt lgkmcnt(15)
    v_mfma_f32_32x32x16_bf16 v[64:79], a[48:51], v[108:111], v[64:79]
    ds_read_b64_tr_b16 v[96:97], v131 offset:40960
    ds_read_b64_tr_b16 v[98:99], v131 offset:41984
    s_waitcnt lgkmcnt(15)
    v_mfma_f32_32x32x16_bf16 v[16:31], a[52:55], v[112:115], v[16:31]
    ds_read_b128 a[60:63], v11 offset:32768
    ds_read_b64_tr_b16 v[100:101], v128 offset:45056
    ds_read_b64_tr_b16 v[102:103], v128 offset:46080
    s_waitcnt lgkmcnt(15)
    v_mfma_f32_32x32x16_bf16 v[32:47], a[52:55], v[116:119], v[32:47]
    ds_read_b64_tr_b16 v[104:105], v129 offset:45056
    ds_read_b64_tr_b16 v[106:107], v129 offset:46080
    s_waitcnt lgkmcnt(15)
    v_mfma_f32_32x32x16_bf16 v[48:63], a[52:55], v[120:123], v[48:63]
    ds_read_b64_tr_b16 v[108:109], v130 offset:45056
    ds_read_b64_tr_b16 v[110:111], v130 offset:46080
    s_waitcnt lgkmcnt(15)
    v_mfma_f32_32x32x16_bf16 v[64:79], a[52:55], v[80:83], v[64:79]
    ds_read_b64_tr_b16 v[112:113], v131 offset:45056
    ds_read_b64_tr_b16 v[114:115], v131 offset:46080
    s_waitcnt lgkmcnt(15)
    v_mfma_f32_32x32x16_bf16 v[16:31], a[56:59], v[84:87], v[16:31]
    s_barrier
    ds_read_b128 a[64:67], v4 offset:0
    ds_read_b64_tr_b16 v[116:117], v124 offset:0
    ds_read_b64_tr_b16 v[118:119], v124 offset:1024
    s_waitcnt lgkmcnt(15)
    v_mfma_f32_32x32x16_bf16 v[32:47], a[56:59], v[88:91], v[32:47]
    ds_read_b64_tr_b16 v[120:121], v125 offset:0
    ds_read_b64_tr_b16 v[122:123], v125 offset:1024
    s_waitcnt lgkmcnt(15)
    v_mfma_f32_32x32x16_bf16 v[48:63], a[56:59], v[92:95], v[48:63]
    ds_read_b64_tr_b16 v[80:81], v126 offset:0
    ds_read_b64_tr_b16 v[82:83], v126 offset:1024
    s_waitcnt lgkmcnt(15)
    v_mfma_f32_32x32x16_bf16 v[64:79], a[56:59], v[96:99], v[64:79]
    ds_read_b64_tr_b16 v[84:85], v127 offset:0
    ds_read_b64_tr_b16 v[86:87], v127 offset:1024
    s_waitcnt lgkmcnt(15)
    v_mfma_f32_32x32x16_bf16 v[16:31], a[60:63], v[100:103], v[16:31]
    ds_read_b128 a[68:71], v5 offset:0
    ds_read_b64_tr_b16 v[88:89], v124 offset:4096
    ds_read_b64_tr_b16 v[90:91], v124 offset:5120
    s_waitcnt lgkmcnt(15)
    v_mfma_f32_32x32x16_bf16 v[32:47], a[60:63], v[104:107], v[32:47]
    ds_read_b64_tr_b16 v[92:93], v125 offset:4096
    ds_read_b64_tr_b16 v[94:95], v125 offset:5120
    s_waitcnt lgkmcnt(15)
    v_mfma_f32_32x32x16_bf16 v[48:63], a[60:63], v[108:111], v[48:63]
    ds_read_b64_tr_b16 v[96:97], v126 offset:4096
    ds_read_b64_tr_b16 v[98:99], v126 offset:5120
    s_waitcnt lgkmcnt(15)
    v_mfma_f32_32x32x16_bf16 v[64:79], a[60:63], v[112:115], v[64:79]
    ds_read_b64_tr_b16 v[100:101], v127 offset:4096
    ds_read_b64_tr_b16 v[102:103], v127 offset:5120
    s_waitcnt lgkmcnt(15)
    v_mfma_f32_32x32x16_bf16 v[16:31], a[64:67], v[116:119], v[16:31]
    ds_read_b128 a[72:75], v6 offset:0
    ds_read_b64_tr_b16 v[104:105], v124 offset:8192
    ds_read_b64_tr_b16 v[106:107], v124 offset:9216
    s_waitcnt lgkmcnt(15)
    v_mfma_f32_32x32x16_bf16 v[32:47], a[64:67], v[120:123], v[32:47]
    ds_read_b64_tr_b16 v[108:109], v125 offset:8192
    ds_read_b64_tr_b16 v[110:111], v125 offset:9216
    s_waitcnt lgkmcnt(15)
    v_mfma_f32_32x32x16_bf16 v[48:63], a[64:67], v[80:83], v[48:63]
    ds_read_b64_tr_b16 v[112:113], v126 offset:8192
    ds_read_b64_tr_b16 v[114:115], v126 offset:9216
    s_waitcnt lgkmcnt(15)
    v_mfma_f32_32x32x16_bf16 v[64:79], a[64:67], v[84:87], v[64:79]
    ds_read_b64_tr_b16 v[116:117], v127 offset:8192
    ds_read_b64_tr_b16 v[118:119], v127 offset:9216
    s_waitcnt lgkmcnt(15)
    v_mfma_f32_32x32x16_bf16 v[16:31], a[68:71], v[88:91], v[16:31]
    ds_read_b128 a[76:79], v7 offset:0
    ds_read_b64_tr_b16 v[120:121], v124 offset:12288
    ds_read_b64_tr_b16 v[122:123], v124 offset:13312
    s_waitcnt lgkmcnt(15)
    v_mfma_f32_32x32x16_bf16 v[32:47], a[68:71], v[92:95], v[32:47]
    ds_read_b64_tr_b16 v[80:81], v125 offset:12288
    ds_read_b64_tr_b16 v[82:83], v125 offset:13312
    s_waitcnt lgkmcnt(15)
    v_mfma_f32_32x32x16_bf16 v[48:63], a[68:71], v[96:99], v[48:63]
    ds_read_b64_tr_b16 v[84:85], v126 offset:12288
    ds_read_b64_tr_b16 v[86:87], v126 offset:13312
    s_waitcnt lgkmcnt(15)
    v_mfma_f32_32x32x16_bf16 v[64:79], a[68:71], v[100:103], v[64:79]
    ds_read_b64_tr_b16 v[88:89], v127 offset:12288
    ds_read_b64_tr_b16 v[90:91], v127 offset:13312
    s_waitcnt lgkmcnt(15)
    v_mfma_f32_32x32x16_bf16 v[16:31], a[72:75], v[104:107], v[16:31]
    s_barrier
    ds_read_b128 a[80:83], v4 offset:32768
    ds_read_b64_tr_b16 v[92:93], v124 offset:32768
    ds_read_b64_tr_b16 v[94:95], v124 offset:33792
    s_waitcnt lgkmcnt(15)
    v_mfma_f32_32x32x16_bf16 v[32:47], a[72:75], v[108:111], v[32:47]
    ds_read_b64_tr_b16 v[96:97], v125 offset:32768
    ds_read_b64_tr_b16 v[98:99], v125 offset:33792
    s_waitcnt lgkmcnt(15)
    v_mfma_f32_32x32x16_bf16 v[48:63], a[72:75], v[112:115], v[48:63]
    ds_read_b64_tr_b16 v[100:101], v126 offset:32768
    ds_read_b64_tr_b16 v[102:103], v126 offset:33792
    s_waitcnt lgkmcnt(15)
    v_mfma_f32_32x32x16_bf16 v[64:79], a[72:75], v[116:119], v[64:79]
    ds_read_b64_tr_b16 v[104:105], v127 offset:32768
    ds_read_b64_tr_b16 v[106:107], v127 offset:33792
    s_waitcnt lgkmcnt(15)
    v_mfma_f32_32x32x16_bf16 v[16:31], a[76:79], v[120:123], v[16:31]
    ds_read_b128 a[84:87], v5 offset:32768
    ds_read_b64_tr_b16 v[108:109], v124 offset:36864
    ds_read_b64_tr_b16 v[110:111], v124 offset:37888
    s_waitcnt lgkmcnt(15)
    v_mfma_f32_32x32x16_bf16 v[32:47], a[76:79], v[80:83], v[32:47]
    ds_read_b64_tr_b16 v[112:113], v125 offset:36864
    ds_read_b64_tr_b16 v[114:115], v125 offset:37888
    s_waitcnt lgkmcnt(15)
    v_mfma_f32_32x32x16_bf16 v[48:63], a[76:79], v[84:87], v[48:63]
    ds_read_b64_tr_b16 v[116:117], v126 offset:36864
    ds_read_b64_tr_b16 v[118:119], v126 offset:37888
    s_waitcnt lgkmcnt(15)
    v_mfma_f32_32x32x16_bf16 v[64:79], a[76:79], v[88:91], v[64:79]
    ds_read_b64_tr_b16 v[120:121], v127 offset:36864
    ds_read_b64_tr_b16 v[122:123], v127 offset:37888
    s_waitcnt lgkmcnt(15)
    v_mfma_f32_32x32x16_bf16 v[16:31], a[80:83], v[92:95], v[16:31]
    ds_read_b128 a[88:91], v6 offset:32768
    ds_read_b64_tr_b16 v[80:81], v124 offset:40960
    ds_read_b64_tr_b16 v[82:83], v124 offset:41984
    s_waitcnt lgkmcnt(15)
    v_mfma_f32_32x32x16_bf16 v[32:47], a[80:83], v[96:99], v[32:47]
    ds_read_b64_tr_b16 v[84:85], v125 offset:40960
    ds_read_b64_tr_b16 v[86:87], v125 offset:41984
    s_waitcnt lgkmcnt(15)
    v_mfma_f32_32x32x16_bf16 v[48:63], a[80:83], v[100:103], v[48:63]
    ds_read_b64_tr_b16 v[88:89], v126 offset:40960
    ds_read_b64_tr_b16 v[90:91], v126 offset:41984
    s_waitcnt lgkmcnt(15)
    v_mfma_f32_32x32x16_bf16 v[64:79], a[80:83], v[104:107], v[64:79]
    ds_read_b64_tr_b16 v[92:93], v127 offset:40960
    ds_read_b64_tr_b16 v[94:95], v127 offset:41984
    s_waitcnt lgkmcnt(15)
    v_mfma_f32_32x32x16_bf16 v[16:31], a[84:87], v[108:111], v[16:31]
    ds_read_b128 a[92:95], v7 offset:32768
    ds_read_b64_tr_b16 v[96:97], v124 offset:45056
    ds_read_b64_tr_b16 v[98:99], v124 offset:46080
    s_waitcnt lgkmcnt(15)
    v_mfma_f32_32x32x16_bf16 v[32:47], a[84:87], v[112:115], v[32:47]
    ds_read_b64_tr_b16 v[100:101], v125 offset:45056
    ds_read_b64_tr_b16 v[102:103], v125 offset:46080
    s_waitcnt lgkmcnt(15)
    v_mfma_f32_32x32x16_bf16 v[48:63], a[84:87], v[116:119], v[48:63]
    ds_read_b64_tr_b16 v[104:105], v126 offset:45056
    ds_read_b64_tr_b16 v[106:107], v126 offset:46080
    s_waitcnt lgkmcnt(15)
    v_mfma_f32_32x32x16_bf16 v[64:79], a[84:87], v[120:123], v[64:79]
    ds_read_b64_tr_b16 v[108:109], v127 offset:45056
    ds_read_b64_tr_b16 v[110:111], v127 offset:46080
    s_waitcnt lgkmcnt(15)
    v_mfma_f32_32x32x16_bf16 v[16:31], a[88:91], v[80:83], v[16:31]
    s_barrier
    ds_read_b128 a[96:99], v8 offset:0
    ds_read_b64_tr_b16 v[112:113], v128 offset:0
    ds_read_b64_tr_b16 v[114:115], v128 offset:1024
    s_waitcnt lgkmcnt(15)
    v_mfma_f32_32x32x16_bf16 v[32:47], a[88:91], v[84:87], v[32:47]
    ds_read_b64_tr_b16 v[116:117], v129 offset:0
    ds_read_b64_tr_b16 v[118:119], v129 offset:1024
    s_waitcnt lgkmcnt(15)
    v_mfma_f32_32x32x16_bf16 v[48:63], a[88:91], v[88:91], v[48:63]
    ds_read_b64_tr_b16 v[120:121], v130 offset:0
    ds_read_b64_tr_b16 v[122:123], v130 offset:1024
    v_mov_b32 v138, 0
    global_load_dwordx2 v[136:137], v138, s[94:95] sc1
    s_waitcnt lgkmcnt(15)
    v_mfma_f32_32x32x16_bf16 v[64:79], a[88:91], v[92:95], v[64:79]
    ds_read_b64_tr_b16 v[80:81], v131 offset:0
    ds_read_b64_tr_b16 v[82:83], v131 offset:1024
    s_waitcnt lgkmcnt(15)
    v_mfma_f32_32x32x16_bf16 v[16:31], a[92:95], v[96:99], v[16:31]
    ds_read_b128 a[100:103], v9 offset:0
    ds_read_b64_tr_b16 v[84:85], v128 offset:4096
    ds_read_b64_tr_b16 v[86:87], v128 offset:5120
    s_waitcnt lgkmcnt(15)
    v_mfma_f32_32x32x16_bf16 v[32:47], a[92:95], v[100:103], v[32:47]
    ds_read_b64_tr_b16 v[88:89], v129 offset:4096
    ds_read_b64_tr_b16 v[90:91], v129 offset:5120
    s_waitcnt lgkmcnt(15)
    v_mfma_f32_32x32x16_bf16 v[48:63], a[92:95], v[104:107], v[48:63]
    ds_read_b64_tr_b16 v[92:93], v130 offset:4096
    ds_read_b64_tr_b16 v[94:95], v130 offset:5120
    s_waitcnt lgkmcnt(15)
    v_mfma_f32_32x32x16_bf16 v[64:79], a[92:95], v[108:111], v[64:79]
    ds_read_b64_tr_b16 v[96:97], v131 offset:4096
    ds_read_b64_tr_b16 v[98:99], v131 offset:5120
    s_waitcnt lgkmcnt(15)
    v_mfma_f32_32x32x16_bf16 v[16:31], a[96:99], v[112:115], v[16:31]
    ds_read_b128 a[104:107], v10 offset:0
    ds_read_b64_tr_b16 v[100:101], v128 offset:8192
    ds_read_b64_tr_b16 v[102:103], v128 offset:9216
    s_waitcnt lgkmcnt(15)
    v_mfma_f32_32x32x16_bf16 v[32:47], a[96:99], v[116:119], v[32:47]
    ds_read_b64_tr_b16 v[104:105], v129 offset:8192
    ds_read_b64_tr_b16 v[106:107], v129 offset:9216
    s_waitcnt lgkmcnt(15)
    v_mfma_f32_32x32x16_bf16 v[48:63], a[96:99], v[120:123], v[48:63]
    ds_read_b64_tr_b16 v[108:109], v130 offset:8192
    ds_read_b64_tr_b16 v[110:111], v130 offset:9216
    s_waitcnt lgkmcnt(15)
    v_mfma_f32_32x32x16_bf16 v[64:79], a[96:99], v[80:83], v[64:79]
    ds_read_b64_tr_b16 v[112:113], v131 offset:8192
    ds_read_b64_tr_b16 v[114:115], v131 offset:9216
    s_waitcnt lgkmcnt(15)
    v_mfma_f32_32x32x16_bf16 v[16:31], a[100:103], v[84:87], v[16:31]
    ds_read_b128 a[108:111], v11 offset:0
    ds_read_b64_tr_b16 v[116:117], v128 offset:12288
    ds_read_b64_tr_b16 v[118:119], v128 offset:13312
    s_waitcnt lgkmcnt(15)
    v_mfma_f32_32x32x16_bf16 v[32:47], a[100:103], v[88:91], v[32:47]
    ds_read_b64_tr_b16 v[120:121], v129 offset:12288
    ds_read_b64_tr_b16 v[122:123], v129 offset:13312
    s_waitcnt lgkmcnt(15)
    v_mfma_f32_32x32x16_bf16 v[48:63], a[100:103], v[92:95], v[48:63]
    ds_read_b64_tr_b16 v[80:81], v130 offset:12288
    ds_read_b64_tr_b16 v[82:83], v130 offset:13312
    s_waitcnt lgkmcnt(15)
    v_mfma_f32_32x32x16_bf16 v[64:79], a[100:103], v[96:99], v[64:79]
    ds_read_b64_tr_b16 v[84:85], v131 offset:12288
    ds_read_b64_tr_b16 v[86:87], v131 offset:13312
    s_waitcnt lgkmcnt(15)
    v_mfma_f32_32x32x16_bf16 v[16:31], a[104:107], v[100:103], v[16:31]
    s_barrier
    ds_read_b64_tr_b16 v[88:89], v15 offset:32768
    ds_read_b64_tr_b16 v[90:91], v15 offset:33280
    s_waitcnt lgkmcnt(15)
    v_mfma_f32_32x32x16_bf16 v[32:47], a[104:107], v[104:107], v[32:47]
    ds_read_b64_tr_b16 v[92:93], v15 offset:36864
    ds_read_b64_tr_b16 v[94:95], v15 offset:37376
    s_waitcnt lgkmcnt(15)
    v_mfma_f32_32x32x16_bf16 v[48:63], a[104:107], v[108:111], v[48:63]
    ds_read_b64_tr_b16 v[96:97], v15 offset:40960
    ds_read_b64_tr_b16 v[98:99], v15 offset:41472
    s_waitcnt lgkmcnt(15)
    v_mfma_f32_32x32x16_bf16 v[64:79], a[104:107], v[112:115], v[64:79]
    ds_read_b64_tr_b16 v[100:101], v15 offset:45056
    ds_read_b64_tr_b16 v[102:103], v15 offset:45568
    s_waitcnt lgkmcnt(14)
    v_mfma_f32_32x32x16_bf16 v[16:31], a[108:111], v[116:119], v[16:31]
    ds_read_b64_tr_b16 v[104:105], v15 offset:33792
    ds_read_b64_tr_b16 v[106:107], v15 offset:34304
    s_waitcnt lgkmcnt(14)
    v_mfma_f32_32x32x16_bf16 v[32:47], a[108:111], v[120:123], v[32:47]
    ds_read_b64_tr_b16 v[108:109], v15 offset:37888
    ds_read_b64_tr_b16 v[110:111], v15 offset:38400
    s_waitcnt lgkmcnt(14)
    v_mfma_f32_32x32x16_bf16 v[48:63], a[108:111], v[80:83], v[48:63]
    ds_read_b64_tr_b16 v[112:113], v15 offset:41984
    ds_read_b64_tr_b16 v[114:115], v15 offset:42496
    s_waitcnt lgkmcnt(14)
    v_mfma_f32_32x32x16_bf16 v[64:79], a[108:111], v[84:87], v[64:79]
    ds_read_b64_tr_b16 v[116:117], v15 offset:46080
    ds_read_b64_tr_b16 v[118:119], v15 offset:46592
    v_cvt_pk_bf16_f32 v16, v16, v17
    v_cvt_pk_bf16_f32 v17, v18, v19
    v_cvt_pk_bf16_f32 v18, v20, v21
    v_cvt_pk_bf16_f32 v19, v22, v23
    v_cvt_pk_bf16_f32 v20, v24, v25
    v_cvt_pk_bf16_f32 v21, v26, v27
    v_cvt_pk_bf16_f32 v22, v28, v29
    v_cvt_pk_bf16_f32 v23, v30, v31
    s_mov_b32 exec_lo, 0xf0000000
    s_mov_b32 exec_hi, 0xf0000000
    v_mov_b32 v16, v134
    v_mov_b32 v17, v134
    v_mov_b32 v18, v134
    v_mov_b32 v19, v134
    s_mov_b64 exec, -1
    buffer_store_dwordx4 v[16:19], v2, s[8:11], s40 offen offset:0 sc0 sc1
    s_mov_b32 exec_lo, 0xf0000000
    s_mov_b32 exec_hi, 0xf0000000
    v_mov_b32 v20, v134
    v_mov_b32 v21, v134
    v_mov_b32 v22, v134
    v_mov_b32 v23, v134
    s_mov_b64 exec, -1
    buffer_store_dwordx4 v[20:23], v2, s[8:11], s40 offen offset:1024 sc0 sc1
    v_cvt_pk_bf16_f32 v24, v32, v33
    v_cvt_pk_bf16_f32 v25, v34, v35
    v_cvt_pk_bf16_f32 v26, v36, v37
    v_cvt_pk_bf16_f32 v27, v38, v39
    v_cvt_pk_bf16_f32 v28, v40, v41
    v_cvt_pk_bf16_f32 v29, v42, v43
    v_cvt_pk_bf16_f32 v30, v44, v45
    v_cvt_pk_bf16_f32 v31, v46, v47
    s_mov_b32 exec_lo, 0xf0000000
    s_mov_b32 exec_hi, 0xf0000000
    v_mov_b32 v24, v134
    v_mov_b32 v25, v134
    v_mov_b32 v26, v134
    v_mov_b32 v27, v134
    s_mov_b64 exec, -1
    buffer_store_dwordx4 v[24:27], v2, s[8:11], s41 offen offset:0 sc0 sc1
    s_mov_b32 exec_lo, 0xf0000000
    s_mov_b32 exec_hi, 0xf0000000
    v_mov_b32 v28, v134
    v_mov_b32 v29, v134
    v_mov_b32 v30, v134
    v_mov_b32 v31, v134
    s_mov_b64 exec, -1
    buffer_store_dwordx4 v[28:31], v2, s[8:11], s41 offen offset:1024 sc0 sc1
    v_cvt_pk_bf16_f32 v32, v48, v49
    v_cvt_pk_bf16_f32 v33, v50, v51
    v_cvt_pk_bf16_f32 v34, v52, v53
    v_cvt_pk_bf16_f32 v35, v54, v55
    v_cvt_pk_bf16_f32 v36, v56, v57
    v_cvt_pk_bf16_f32 v37, v58, v59
    v_cvt_pk_bf16_f32 v38, v60, v61
    v_cvt_pk_bf16_f32 v39, v62, v63
    v_cvt_pk_bf16_f32 v40, v64, v65
    v_cvt_pk_bf16_f32 v41, v66, v67
    v_cvt_pk_bf16_f32 v42, v68, v69
    v_cvt_pk_bf16_f32 v43, v70, v71
    v_cvt_pk_bf16_f32 v44, v72, v73
    v_cvt_pk_bf16_f32 v45, v74, v75
    v_cvt_pk_bf16_f32 v46, v76, v77
    v_cvt_pk_bf16_f32 v47, v78, v79
    s_mov_b32 exec_lo, 0xf0000000
    s_mov_b32 exec_hi, 0xf0000000
    v_mov_b32 v32, v134
    v_mov_b32 v33, v134
    v_mov_b32 v34, v134
    v_mov_b32 v35, v134
    s_mov_b64 exec, -1
    s_waitcnt lgkmcnt(14)
    v_mfma_f32_32x32x16_bf16 v[64:79], v[88:91], a[0:3], 0
    ds_read_b64_tr_b16 v[120:121], v15 offset:49152
    ds_read_b64_tr_b16 v[122:123], v15 offset:49664
    buffer_store_dwordx4 v[32:35], v2, s[8:11], s42 offen offset:0 sc0 sc1
    s_waitcnt lgkmcnt(14)
    v_mfma_f32_32x32x16_bf16 v[64:79], v[92:95], a[4:7], v[64:79]
    ds_read_b64_tr_b16 v[80:81], v15 offset:53248
    ds_read_b64_tr_b16 v[82:83], v15 offset:53760
    s_mov_b32 exec_lo, 0xf0000000
    s_mov_b32 exec_hi, 0xf0000000
    v_mov_b32 v36, v134
    v_mov_b32 v37, v134
    v_mov_b32 v38, v134
    v_mov_b32 v39, v134
    s_mov_b64 exec, -1
    s_waitcnt lgkmcnt(14)
    v_mfma_f32_32x32x16_bf16 v[64:79], v[96:99], a[8:11], v[64:79]
    ds_read_b64_tr_b16 v[84:85], v15 offset:57344
    ds_read_b64_tr_b16 v[86:87], v15 offset:57856
    buffer_store_dwordx4 v[36:39], v2, s[8:11], s42 offen offset:1024 sc0 sc1
    s_waitcnt lgkmcnt(14)
    v_mfma_f32_32x32x16_bf16 v[64:79], v[100:103], a[12:15], v[64:79]
    ds_read_b64_tr_b16 v[88:89], v15 offset:61440
    ds_read_b64_tr_b16 v[90:91], v15 offset:61952
    s_mov_b32 exec_lo, 0xf0000000
    s_mov_b32 exec_hi, 0xf0000000
    v_mov_b32 v40, v134
    v_mov_b32 v41, v134
    v_mov_b32 v42, v134
    v_mov_b32 v43, v134
    s_mov_b64 exec, -1
    s_waitcnt lgkmcnt(14)
    v_mfma_f32_32x32x16_bf16 v[64:79], v[104:107], a[16:19], v[64:79]
    ds_read_b64_tr_b16 v[92:93], v15 offset:50176
    ds_read_b64_tr_b16 v[94:95], v15 offset:50688
    buffer_store_dwordx4 v[40:43], v2, s[8:11], s43 offen offset:0 sc0 sc1
    s_waitcnt lgkmcnt(14)
    v_mfma_f32_32x32x16_bf16 v[64:79], v[108:111], a[20:23], v[64:79]
    ds_read_b64_tr_b16 v[96:97], v15 offset:54272
    ds_read_b64_tr_b16 v[98:99], v15 offset:54784
    s_mov_b32 exec_lo, 0xf0000000
    s_mov_b32 exec_hi, 0xf0000000
    v_mov_b32 v44, v134
    v_mov_b32 v45, v134
    v_mov_b32 v46, v134
    v_mov_b32 v47, v134
    s_mov_b64 exec, -1
    s_waitcnt lgkmcnt(14)
    v_mfma_f32_32x32x16_bf16 v[64:79], v[112:115], a[24:27], v[64:79]
    ds_read_b64_tr_b16 v[100:101], v15 offset:58368
    ds_read_b64_tr_b16 v[102:103], v15 offset:58880
    buffer_store_dwordx4 v[44:47], v2, s[8:11], s43 offen offset:1024 sc0 sc1
    s_waitcnt lgkmcnt(14)
    v_mfma_f32_32x32x16_bf16 v[64:79], v[116:119], a[28:31], v[64:79]
    ds_read_b64_tr_b16 v[104:105], v15 offset:62464
    ds_read_b64_tr_b16 v[106:107], v15 offset:62976
    s_waitcnt lgkmcnt(14)
    v_mfma_f32_32x32x16_bf16 v[64:79], v[120:123], a[32:35], v[64:79]
    s_barrier
    ds_read_b64_tr_b16 v[108:109], v13 offset:0
    ds_read_b64_tr_b16 v[110:111], v13 offset:512
    s_waitcnt lgkmcnt(14)
    v_mfma_f32_32x32x16_bf16 v[64:79], v[80:83], a[36:39], v[64:79]
    ds_read_b64_tr_b16 v[112:113], v13 offset:4096
    ds_read_b64_tr_b16 v[114:115], v13 offset:4608
    s_waitcnt lgkmcnt(14)
    v_mfma_f32_32x32x16_bf16 v[64:79], v[84:87], a[40:43], v[64:79]
    ds_read_b64_tr_b16 v[116:117], v13 offset:8192
    ds_read_b64_tr_b16 v[118:119], v13 offset:8704
    s_waitcnt lgkmcnt(14)
    v_mfma_f32_32x32x16_bf16 v[64:79], v[88:91], a[44:47], v[64:79]
    ds_read_b64_tr_b16 v[120:121], v13 offset:12288
    ds_read_b64_tr_b16 v[122:123], v13 offset:12800
    s_waitcnt lgkmcnt(14)
    v_mfma_f32_32x32x16_bf16 v[64:79], v[92:95], a[48:51], v[64:79]
    ds_read_b64_tr_b16 v[80:81], v13 offset:1024
    ds_read_b64_tr_b16 v[82:83], v13 offset:1536
    s_waitcnt lgkmcnt(14)
    v_mfma_f32_32x32x16_bf16 v[64:79], v[96:99], a[52:55], v[64:79]
    ds_read_b64_tr_b16 v[84:85], v13 offset:5120
    ds_read_b64_tr_b16 v[86:87], v13 offset:5632
    s_waitcnt lgkmcnt(14)
    v_mfma_f32_32x32x16_bf16 v[64:79], v[100:103], a[56:59], v[64:79]
    ds_read_b64_tr_b16 v[88:89], v13 offset:9216
    ds_read_b64_tr_b16 v[90:91], v13 offset:9728
    s_waitcnt lgkmcnt(14)
    v_mfma_f32_32x32x16_bf16 v[64:79], v[104:107], a[60:63], v[64:79]
    ds_read_b64_tr_b16 v[92:93], v13 offset:13312
    ds_read_b64_tr_b16 v[94:95], v13 offset:13824
    s_waitcnt lgkmcnt(14)
    v_mfma_f32_32x32x16_bf16 v[64:79], v[108:111], a[64:67], v[64:79]
    ds_read_b64_tr_b16 v[96:97], v13 offset:16384
    ds_read_b64_tr_b16 v[98:99], v13 offset:16896
    s_waitcnt lgkmcnt(14)
    v_mfma_f32_32x32x16_bf16 v[64:79], v[112:115], a[68:71], v[64:79]
    ds_read_b64_tr_b16 v[100:101], v13 offset:20480
    ds_read_b64_tr_b16 v[102:103], v13 offset:20992
    s_waitcnt lgkmcnt(14)
    v_mfma_f32_32x32x16_bf16 v[64:79], v[116:119], a[72:75], v[64:79]
    ds_read_b64_tr_b16 v[104:105], v13 offset:24576
    ds_read_b64_tr_b16 v[106:107], v13 offset:25088
    s_waitcnt lgkmcnt(14)
    v_mfma_f32_32x32x16_bf16 v[64:79], v[120:123], a[76:79], v[64:79]
    ds_read_b64_tr_b16 v[108:109], v13 offset:28672
    ds_read_b64_tr_b16 v[110:111], v13 offset:29184
    s_waitcnt lgkmcnt(14)
    v_mfma_f32_32x32x16_bf16 v[64:79], v[80:83], a[80:83], v[64:79]
    ds_read_b64_tr_b16 v[112:113], v14 offset:32768
    ds_read_b64_tr_b16 v[114:115], v14 offset:33280
    s_waitcnt lgkmcnt(14)
    v_mfma_f32_32x32x16_bf16 v[64:79], v[84:87], a[84:87], v[64:79]
    ds_read_b64_tr_b16 v[116:117], v14 offset:36864
    ds_read_b64_tr_b16 v[118:119], v14 offset:37376
    s_waitcnt lgkmcnt(14)
    v_mfma_f32_32x32x16_bf16 v[64:79], v[88:91], a[88:91], v[64:79]
    ds_read_b64_tr_b16 v[120:121], v14 offset:40960
    ds_read_b64_tr_b16 v[122:123], v14 offset:41472
    s_waitcnt lgkmcnt(14)
    v_mfma_f32_32x32x16_bf16 v[64:79], v[92:95], a[92:95], v[64:79]
    ds_read_b64_tr_b16 v[80:81], v14 offset:45056
    ds_read_b64_tr_b16 v[82:83], v14 offset:45568
    s_waitcnt lgkmcnt(14)
    v_mfma_f32_32x32x16_bf16 v[64:79], v[96:99], a[96:99], v[64:79]
    ds_read_b64_tr_b16 v[84:85], v14 offset:33792
    ds_read_b64_tr_b16 v[86:87], v14 offset:34304
    s_waitcnt lgkmcnt(14)
    v_mfma_f32_32x32x16_bf16 v[64:79], v[100:103], a[100:103], v[64:79]
    ds_read_b64_tr_b16 v[88:89], v14 offset:37888
    ds_read_b64_tr_b16 v[90:91], v14 offset:38400
    s_waitcnt lgkmcnt(14)
    v_mfma_f32_32x32x16_bf16 v[64:79], v[104:107], a[104:107], v[64:79]
    ds_read_b64_tr_b16 v[92:93], v14 offset:41984
    ds_read_b64_tr_b16 v[94:95], v14 offset:42496
    s_waitcnt lgkmcnt(14)
    v_mfma_f32_32x32x16_bf16 v[64:79], v[108:111], a[108:111], v[64:79]
    ds_read_b64_tr_b16 v[96:97], v14 offset:46080
    ds_read_b64_tr_b16 v[98:99], v14 offset:46592
    s_mov_b32 s63, 0
TAG_L18:
    s_waitcnt vmcnt(0)
    v_readfirstlane_b32 s60, v136
    v_readfirstlane_b32 s61, v137
    s_nop 1
    s_cmp_lg_u32 s60, 0
    s_cbranch_scc1 TAG_OK18
    s_add_u32 s63, s63, 1
    s_cmp_gt_u32 s63, 131072
    s_cbranch_scc1 KERNEL_END
    global_load_dwordx2 v[136:137], v138, s[94:95] sc1
    s_branch TAG_L18
TAG_OK18:
    v_mov_b32 v136, 159744
    v_mov_b32 v137, 1
    s_mov_b32 exec_lo, 1
    s_mov_b32 exec_hi, 0
    ds_add_rtn_u32 v138, v136, v137
    s_mov_b64 exec, -1
    s_waitcnt lgkmcnt(0)
    v_readfirstlane_b32 s3, v138
    s_nop 1
    s_cmp_lg_u32 s3, 3
    s_cbranch_scc1 NOTLAST19
    v_mov_b32 v136, s60
    v_mov_b32 v137, s61
    v_lshlrev_b32 v138, 3, v1
    s_mov_b32 exec_lo, 1
    s_mov_b32 exec_hi, 0
    buffer_store_dwordx2 v[136:137], v138, s[8:11], s31 offen sc1
    s_mov_b64 exec, -1
NOTLAST19:
    v_mfma_f32_32x32x16_bf16 v[48:63], v[112:115], a[0:3], 0
    ds_read_b64_tr_b16 v[100:101], v14 offset:49152
    ds_read_b64_tr_b16 v[102:103], v14 offset:49664
    v_mfma_f32_32x32x16_bf16 v[48:63], v[116:119], a[4:7], v[48:63]
    ds_read_b64_tr_b16 v[104:105], v14 offset:53248
    ds_read_b64_tr_b16 v[106:107], v14 offset:53760
    v_mfma_f32_32x32x16_bf16 v[48:63], v[120:123], a[8:11], v[48:63]
    ds_read_b64_tr_b16 v[108:109], v14 offset:57344
    ds_read_b64_tr_b16 v[110:111], v14 offset:57856
    v_pk_mul_f32 v[64:65], v[64:65], s[36:37]
    v_pk_mul_f32 v[66:67], v[66:67], s[36:37]
    v_pk_mul_f32 v[68:69], v[68:69], s[36:37]
    v_pk_mul_f32 v[70:71], v[70:71], s[36:37]
    v_mfma_f32_32x32x16_bf16 v[48:63], v[80:83], a[12:15], v[48:63]
    ds_read_b64_tr_b16 v[112:113], v14 offset:61440
    ds_read_b64_tr_b16 v[114:115], v14 offset:61952
    v_pk_mul_f32 v[72:73], v[72:73], s[36:37]
    v_pk_mul_f32 v[74:75], v[74:75], s[36:37]
    v_pk_mul_f32 v[76:77], v[76:77], s[36:37]
    v_pk_mul_f32 v[78:79], v[78:79], s[36:37]
    v_mfma_f32_32x32x16_bf16 v[48:63], v[84:87], a[16:19], v[48:63]
    ds_read_b64_tr_b16 v[116:117], v14 offset:50176
    ds_read_b64_tr_b16 v[118:119], v14 offset:50688
    v_cvt_pk_bf16_f32 v64, v64, v65
    v_cvt_pk_bf16_f32 v65, v66, v67
    v_cvt_pk_bf16_f32 v66, v68, v69
    v_cvt_pk_bf16_f32 v67, v70, v71
    v_mfma_f32_32x32x16_bf16 v[48:63], v[88:91], a[20:23], v[48:63]
    ds_read_b64_tr_b16 v[120:121], v14 offset:54272
    ds_read_b64_tr_b16 v[122:123], v14 offset:54784
    v_cvt_pk_bf16_f32 v68, v72, v73
    v_cvt_pk_bf16_f32 v69, v74, v75
    v_cvt_pk_bf16_f32 v70, v76, v77
    v_cvt_pk_bf16_f32 v71, v78, v79
    v_mfma_f32_32x32x16_bf16 v[48:63], v[92:95], a[24:27], v[48:63]
    ds_read_b64_tr_b16 v[80:81], v14 offset:58368
    ds_read_b64_tr_b16 v[82:83], v14 offset:58880
    s_mov_b32 exec_lo, 0
    v_mov_b32 v70, 0
    v_mov_b32 v71, 0
    s_mov_b32 exec_lo, -1
    v_mfma_f32_32x32x16_bf16 v[48:63], v[96:99], a[28:31], v[48:63]
    ds_read_b64_tr_b16 v[84:85], v14 offset:62464
    ds_read_b64_tr_b16 v[86:87], v14 offset:62976
    buffer_store_dwordx4 v[64:67], v2, s[8:11], s45 offen sc0 sc1
    s_waitcnt lgkmcnt(14)
    v_mfma_f32_32x32x16_bf16 v[48:63], v[100:103], a[32:35], v[48:63]
    ds_read_b64_tr_b16 v[88:89], v12 offset:0
    ds_read_b64_tr_b16 v[90:91], v12 offset:512
    buffer_store_dwordx4 v[68:71], v2, s[8:11], s45 offen offset:1024 sc0 sc1
    s_waitcnt lgkmcnt(14)
    v_mfma_f32_32x32x16_bf16 v[48:63], v[104:107], a[36:39], v[48:63]
    ds_read_b64_tr_b16 v[92:93], v12 offset:4096
    ds_read_b64_tr_b16 v[94:95], v12 offset:4608
    s_waitcnt lgkmcnt(14)
    v_mfma_f32_32x32x16_bf16 v[48:63], v[108:111], a[40:43], v[48:63]
    ds_read_b64_tr_b16 v[96:97], v12 offset:8192
    ds_read_b64_tr_b16 v[98:99], v12 offset:8704
    s_waitcnt lgkmcnt(14)
    v_mfma_f32_32x32x16_bf16 v[48:63], v[112:115], a[44:47], v[48:63]
    ds_read_b64_tr_b16 v[100:101], v12 offset:12288
    ds_read_b64_tr_b16 v[102:103], v12 offset:12800
    s_waitcnt lgkmcnt(14)
    v_mfma_f32_32x32x16_bf16 v[48:63], v[116:119], a[48:51], v[48:63]
    ds_read_b64_tr_b16 v[104:105], v12 offset:1024
    ds_read_b64_tr_b16 v[106:107], v12 offset:1536
    s_waitcnt lgkmcnt(14)
    v_mfma_f32_32x32x16_bf16 v[48:63], v[120:123], a[52:55], v[48:63]
    ds_read_b64_tr_b16 v[108:109], v12 offset:5120
    ds_read_b64_tr_b16 v[110:111], v12 offset:5632
    s_waitcnt lgkmcnt(14)
    v_mfma_f32_32x32x16_bf16 v[48:63], v[80:83], a[56:59], v[48:63]
    ds_read_b64_tr_b16 v[112:113], v12 offset:9216
    ds_read_b64_tr_b16 v[114:115], v12 offset:9728
    s_waitcnt lgkmcnt(14)
    v_mfma_f32_32x32x16_bf16 v[48:63], v[84:87], a[60:63], v[48:63]
    ds_read_b64_tr_b16 v[116:117], v12 offset:13312
    ds_read_b64_tr_b16 v[118:119], v12 offset:13824
    s_waitcnt lgkmcnt(14)
    v_mfma_f32_32x32x16_bf16 v[48:63], v[88:91], a[64:67], v[48:63]
    ds_read_b64_tr_b16 v[120:121], v12 offset:16384
    ds_read_b64_tr_b16 v[122:123], v12 offset:16896
    s_waitcnt lgkmcnt(14)
    v_mfma_f32_32x32x16_bf16 v[48:63], v[92:95], a[68:71], v[48:63]
    ds_read_b64_tr_b16 v[80:81], v12 offset:20480
    ds_read_b64_tr_b16 v[82:83], v12 offset:20992
    s_waitcnt lgkmcnt(14)
    v_mfma_f32_32x32x16_bf16 v[48:63], v[96:99], a[72:75], v[48:63]
    ds_read_b64_tr_b16 v[84:85], v12 offset:24576
    ds_read_b64_tr_b16 v[86:87], v12 offset:25088
    s_waitcnt lgkmcnt(14)
    v_mfma_f32_32x32x16_bf16 v[48:63], v[100:103], a[76:79], v[48:63]
    ds_read_b64_tr_b16 v[88:89], v12 offset:28672
    ds_read_b64_tr_b16 v[90:91], v12 offset:29184
    s_waitcnt lgkmcnt(14)
    v_mfma_f32_32x32x16_bf16 v[48:63], v[104:107], a[80:83], v[48:63]
    s_waitcnt lgkmcnt(12)
    v_mfma_f32_32x32x16_bf16 v[48:63], v[108:111], a[84:87], v[48:63]
    s_waitcnt lgkmcnt(10)
    v_mfma_f32_32x32x16_bf16 v[48:63], v[112:115], a[88:91], v[48:63]
    s_waitcnt lgkmcnt(8)
    v_mfma_f32_32x32x16_bf16 v[48:63], v[116:119], a[92:95], v[48:63]
    s_add_u32 s31, s31, 2048
    s_cmp_lg_u32 s20, 0
    s_cbranch_scc1 NOQF20
    s_waitcnt vmcnt(0)
    v_mov_b32 v136, 159748
    v_mov_b32 v137, 1
    s_mov_b32 exec_lo, 1
    s_mov_b32 exec_hi, 0
    ds_add_rtn_u32 v138, v136, v137
    s_mov_b64 exec, -1
    s_waitcnt lgkmcnt(0)
    v_readfirstlane_b32 s3, v138
    s_nop 1
    s_cmp_lg_u32 s3, 3
    s_cbranch_scc1 NOTLAST21
    v_mov_b32 v136, s60
    v_mov_b32 v137, s61
    v_lshlrev_b32 v138, 3, v1
    s_mov_b32 exec_lo, 1
    s_mov_b32 exec_hi, 0
    buffer_store_dwordx2 v[136:137], v138, s[8:11], s31 offen sc1
    s_mov_b64 exec, -1
NOTLAST21:
NOQF20:
    s_waitcnt lgkmcnt(6)
    v_mfma_f32_32x32x16_bf16 v[48:63], v[120:123], a[96:99], v[48:63]
    s_waitcnt lgkmcnt(4)
    v_mfma_f32_32x32x16_bf16 v[48:63], v[80:83], a[100:103], v[48:63]
    s_waitcnt lgkmcnt(2)
    v_mfma_f32_32x32x16_bf16 v[48:63], v[84:87], a[104:107], v[48:63]
    s_waitcnt lgkmcnt(0)
    v_mfma_f32_32x32x16_bf16 v[48:63], v[88:91], a[108:111], v[48:63]
    s_nop 11
    v_pk_mul_f32 v[48:49], v[48:49], s[36:37]
    v_pk_mul_f32 v[50:51], v[50:51], s[36:37]
    v_pk_mul_f32 v[52:53], v[52:53], s[36:37]
    v_pk_mul_f32 v[54:55], v[54:55], s[36:37]
    v_pk_mul_f32 v[56:57], v[56:57], s[36:37]
    v_pk_mul_f32 v[58:59], v[58:59], s[36:37]
    v_pk_mul_f32 v[60:61], v[60:61], s[36:37]
    v_pk_mul_f32 v[62:63], v[62:63], s[36:37]
    v_cvt_pk_bf16_f32 v48, v48, v49
    v_cvt_pk_bf16_f32 v49, v50, v51
    v_cvt_pk_bf16_f32 v50, v52, v53
    v_cvt_pk_bf16_f32 v51, v54, v55
    v_cvt_pk_bf16_f32 v52, v56, v57
    v_cvt_pk_bf16_f32 v53, v58, v59
    v_cvt_pk_bf16_f32 v54, v60, v61
    v_cvt_pk_bf16_f32 v55, v62, v63
    s_mov_b32 exec_lo, 0
    v_mov_b32 v54, 0
    v_mov_b32 v55, 0
    s_mov_b32 exec_lo, -1
    ds_write_b128 v3, v[48:51]
    ds_write_b128 v3, v[52:55] offset:1024
P1_DONE:
    s_cmp_eq_u32 s20, 0
    s_cbranch_scc1 P2_NOQ0
    buffer_store_dwordx4 v[48:51], v2, s[8:11], s44 offen sc0 sc1
    buffer_store_dwordx4 v[52:55], v2, s[8:11], s44 offen offset:1024 sc0 sc1
P2_NOQ0:
    s_lshl_b32 s24, s22, 1
    s_add_u32 s24, s24, s20
    v_lshlrev_b32 v4, 4, v1
    s_lshl_b32 s25, s21, 2
    s_lshl_b32 s32, s62, 4
    s_lshl_b32 s48, s24, 6
    s_add_u32 s32, s32, s48
    s_lshl_b32 s32, s32, 12
    s_add_u32 s32, s32, 4194304
    s_add_u32 s12, s4, s32
    s_addc_u32 s13, s5, 0
    s_and_b32 s13, s13, 0xffff
    s_mov_b32 s14, 65536
    s_mov_b32 s15, 0x20000
    s_movk_i32 s44, 0
    s_movk_i32 s45, 4096
    s_movk_i32 s46, 8192
    s_movk_i32 s47, 12288
    s_add_u32 s33, s62, 0
    s_and_b32 s40, s33, 3
    s_add_u32 s33, s62, 1
    s_and_b32 s41, s33, 3
    s_add_u32 s33, s62, 2
    s_and_b32 s42, s33, 3
    s_add_u32 s33, s62, 3
    s_and_b32 s43, s33, 3
    v_accvgpr_write_b32 a56, 0
    v_accvgpr_write_b32 a57, 0
    v_accvgpr_write_b32 a58, 0
    v_accvgpr_write_b32 a59, 0
    v_accvgpr_write_b32 a60, 0
    v_accvgpr_write_b32 a61, 0
    v_accvgpr_write_b32 a62, 0
    v_accvgpr_write_b32 a63, 0
    v_mov_b32 v64, 0
    v_mov_b32 v65, 0
    v_mov_b32 v66, 0
    v_mov_b32 v67, 0
    v_mov_b32 v68, 0
    v_mov_b32 v69, 0
    v_mov_b32 v70, 0
    v_mov_b32 v71, 0
    v_mov_b32 v72, 0
    v_mov_b32 v73, 0
    v_mov_b32 v74, 0
    v_mov_b32 v75, 0
    v_mov_b32 v76, 0
    v_mov_b32 v77, 0
    v_mov_b32 v78, 0
    v_mov_b32 v79, 0
    v_mov_b32 v80, 0
    v_mov_b32 v81, 0
    v_mov_b32 v82, 0
    v_mov_b32 v83, 0
    v_mov_b32 v84, 0
    v_mov_b32 v85, 0
    v_mov_b32 v86, 0
    v_mov_b32 v87, 0
    v_mov_b32 v88, 0
    v_mov_b32 v89, 0
    v_mov_b32 v90, 0
    v_mov_b32 v91, 0
    v_mov_b32 v92, 0
    v_mov_b32 v93, 0
    v_mov_b32 v94, 0
    v_mov_b32 v95, 0
    v_mov_b32 v96, 0
    v_mov_b32 v97, 0
    v_mov_b32 v98, 0
    v_mov_b32 v99, 0
    v_mov_b32 v100, 0
    v_mov_b32 v101, 0
    v_mov_b32 v102, 0
    v_mov_b32 v103, 0
    v_mov_b32 v104, 0
    v_mov_b32 v105, 0
    v_mov_b32 v106, 0
    v_mov_b32 v107, 0
    v_mov_b32 v108, 0
    v_mov_b32 v109, 0
    v_mov_b32 v110, 0
    v_mov_b32 v111, 0
    v_mov_b32 v112, 0
    v_mov_b32 v113, 0
    v_mov_b32 v114, 0
    v_mov_b32 v115, 0
    v_mov_b32 v116, 0
    v_mov_b32 v117, 0
    v_mov_b32 v118, 0
    v_mov_b32 v119, 0
    v_mov_b32 v120, 0
    v_mov_b32 v121, 0
    v_mov_b32 v122, 0
    v_mov_b32 v123, 0
    v_mov_b32 v124, 0
    v_mov_b32 v125, 0
    v_mov_b32 v126, 0
    v_mov_b32 v127, 0
    s_add_u32 s38, s25, s62
    s_lshl_b32 s38, s38, 4
    s_add_u32 s39, s38, s24
    s_lshl_b32 s38, s39, 11
    s_add_u32 s38, s38, 12582912
    s_lshl_b32 s39, s21, 4
    s_add_u32 s39, s39, s24
    s_lshl_b32 s39, s39, 3
    s_add_u32 s39, s39, 16781312
    s_cmp_eq_u32 s20, 0
    s_cbranch_scc1 P2_NOQF
    s_waitcnt vmcnt(0)
    v_mov_b32 v128, 159748
    v_mov_b32 v129, 1
    s_mov_b32 exec_lo, 1
    s_mov_b32 exec_hi, 0
    ds_add_rtn_u32 v130, v128, v129
    s_mov_b64 exec, -1
    s_waitcnt lgkmcnt(0)
    v_readfirstlane_b32 s3, v130
    s_nop 1
    s_cmp_lg_u32 s3, 3
    s_cbranch_scc1 NOTLAST22
    v_mov_b32 v128, s60
    v_mov_b32 v129, s61
    v_lshlrev_b32 v130, 3, v1
    s_mov_b32 exec_lo, 1
    s_mov_b32 exec_hi, 0
    buffer_store_dwordx2 v[128:129], v130, s[8:11], s31 offen sc1
    s_mov_b64 exec, -1
NOTLAST22:
P2_NOQF:
    s_barrier
    s_lshl_b32 s33, s40, 11
    s_add_u32 s33, s33, 151552
    v_add_u32 v6, s33, v4
    s_lshl_b32 s33, s41, 11
    s_add_u32 s33, s33, 151552
    v_add_u32 v7, s33, v4
    s_lshl_b32 s33, s42, 11
    s_add_u32 s33, s33, 151552
    v_add_u32 v8, s33, v4
    s_lshl_b32 s33, s43, 11
    s_add_u32 s33, s33, 151552
    v_add_u32 v9, s33, v4
    v_mov_b32 v56, 0
    v_mov_b32 v57, 0
    v_mov_b32 v58, 0
    v_mov_b32 v59, 0
    v_mov_b32 v60, 0
    v_mov_b32 v61, 0
    v_mov_b32 v62, 0
    v_mov_b32 v63, 0
    v_mov_b32 v5, v4
    s_waitcnt lgkmcnt(0)
    s_barrier
    buffer_load_dwordx4 a[0:3], v5, s[12:15], s44 offen sc1
    buffer_load_dwordx4 a[4:7], v5, s[12:15], s44 offen offset:1024 sc1
    ds_read_b128 a[64:67], v6
    ds_read_b128 a[68:71], v6 offset:1024
    ds_read_b128 a[72:75], v7
    ds_read_b128 a[76:79], v7 offset:1024
    ds_read_b128 a[80:83], v8
    ds_read_b128 a[84:87], v8 offset:1024
    ds_read_b128 a[88:91], v9
    ds_read_b128 a[92:95], v9 offset:1024
    buffer_load_dwordx4 a[8:11], v5, s[12:15], s44 offen offset:2048 sc1
    buffer_load_dwordx4 a[12:15], v5, s[12:15], s44 offen offset:3072 sc1
    buffer_load_dwordx4 a[16:19], v5, s[12:15], s45 offen sc1
    buffer_load_dwordx4 a[20:23], v5, s[12:15], s45 offen offset:1024 sc1
    buffer_load_dwordx4 a[24:27], v5, s[12:15], s45 offen offset:2048 sc1
    buffer_load_dwordx4 a[28:31], v5, s[12:15], s45 offen offset:3072 sc1
    buffer_load_dwordx4 a[32:35], v5, s[12:15], s46 offen sc1
    buffer_load_dwordx4 a[36:39], v5, s[12:15], s46 offen offset:1024 sc1
    buffer_load_dwordx4 a[40:43], v5, s[12:15], s46 offen offset:2048 sc1
    buffer_load_dwordx4 a[44:47], v5, s[12:15], s46 offen offset:3072 sc1
    buffer_load_dwordx4 a[48:51], v5, s[12:15], s47 offen sc1
    buffer_load_dwordx4 a[52:55], v5, s[12:15], s47 offen offset:1024 sc1
    s_setprio 2
    v_lshlrev_b32 v10, 3, v1
    s_lshl_b32 s33, s40, 8
    s_add_u32 s33, s33, 147200
    v_add_u32 v6, s33, v10
    s_lshl_b32 s33, s41, 8
    s_add_u32 s33, s33, 147200
    v_add_u32 v7, s33, v10
    s_lshl_b32 s33, s42, 8
    s_add_u32 s33, s33, 147200
    v_add_u32 v8, s33, v10
    s_lshl_b32 s33, s43, 8
    s_add_u32 s33, s33, 147200
    v_add_u32 v9, s33, v10
    s_mov_b32 s34, 0x07060302
    s_waitcnt vmcnt(12) lgkmcnt(0)
    v_mfma_f32_32x32x16_bf16 v[16:31], a[0:3], a[64:67], 0
    v_mfma_f32_32x32x16_bf16 v[16:31], a[4:7], a[68:71], v[16:31]
    s_nop 11
    v_max3_f32 v10, v16, v17, v18
    v_max3_f32 v10, v10, v19, v20
    v_max3_f32 v10, v10, v21, v22
    v_max3_f32 v10, v10, v23, v24
    v_max3_f32 v10, v10, v25, v26
    v_max3_f32 v10, v10, v27, v28
    v_max3_f32 v10, v10, v29, v30
    v_max_f32 v10, v10, v31
    v_mov_b32 v11, v10
    s_nop 1
    v_permlane32_swap_b32 v10, v11
    v_max_f32 v10, v10, v11
    v_sub_f32 v10, 0xc2000000, v10
    v_and_b32 v11, 0xffff0000, v10
    v_sub_f32 v10, v10, v11
    v_and_b32 v12, 0xffff0000, v10
    v_sub_f32 v10, v10, v12
    v_perm_b32 v14, v12, v11, s34
    v_lshrrev_b32 v15, 16, v10
    s_mov_b32 exec_lo, 0
    ds_write_b64 v6, v[14:15]
    v_accvgpr_write_b32 a70, v14
    v_accvgpr_write_b32 a71, v15
    s_mov_b32 exec_lo, -1
    s_waitcnt lgkmcnt(0)
    s_barrier
    s_mov_b32 exec_lo, 0
    ds_read_b64 a[78:79], v7
    ds_read_b64 a[86:87], v8
    ds_read_b64 a[94:95], v9
    s_mov_b32 exec_lo, -1
    v_mfma_f32_32x32x16_bf16 v[16:31], a[0:3], a[64:67], 0
    v_mfma_f32_32x32x16_bf16 v[16:31], a[4:7], a[68:71], v[16:31]
    s_waitcnt lgkmcnt(0)
    s_mov_b32 s35, 4
    s_mov_b32 s36, 0
    s_nop 7
.p2align 6
P2_LOOP:
    v_mfma_f32_32x32x16_bf16 v[32:47], a[0:3], a[72:75], 0
    v_exp_f32 v16, v16
    v_exp_f32 v17, v17
    v_exp_f32 v18, v18
    v_exp_f32 v19, v19
    v_mfma_f32_32x32x16_bf16 v[32:47], a[4:7], a[76:79], v[32:47]
    v_exp_f32 v20, v20
    v_exp_f32 v21, v21
    v_exp_f32 v22, v22
    v_exp_f32 v23, v23
    v_cvt_pk_bf16_f32 v48, v16, v17
    v_cvt_pk_bf16_f32 v49, v18, v19
    v_mfma_f32_32x32x16_bf16 v[112:127], a[56:59], v[56:59], v[112:127]
    v_exp_f32 v24, v24
    v_exp_f32 v25, v25
    v_exp_f32 v26, v26
    v_exp_f32 v27, v27
    v_cvt_pk_bf16_f32 v50, v20, v21
    v_cvt_pk_bf16_f32 v51, v22, v23
    v_mfma_f32_32x32x16_bf16 v[112:127], a[60:63], v[60:63], v[112:127]
    buffer_load_dwordx4 a[56:59], v5, s[12:15], s47 offen offset:2048 sc1
    v_exp_f32 v28, v28
    v_exp_f32 v29, v29
    v_exp_f32 v30, v30
    v_exp_f32 v31, v31
    buffer_load_dwordx4 a[60:63], v5, s[12:15], s47 offen offset:3072 sc1
    v_cvt_pk_bf16_f32 v52, v24, v25
    v_cvt_pk_bf16_f32 v53, v26, v27
    v_cvt_pk_bf16_f32 v54, v28, v29
    v_cvt_pk_bf16_f32 v55, v30, v31
    v_mfma_f32_32x32x16_bf16 v[16:31], a[0:3], a[80:83], 0
    v_exp_f32 v32, v32
    s_add_u32 s44, s44, 16384
    v_exp_f32 v33, v33
    v_exp_f32 v34, v34
    s_cmp_eq_u32 s35, 1
    v_exp_f32 v35, v35
    v_mfma_f32_32x32x16_bf16 v[16:31], a[4:7], a[84:87], v[16:31]
    v_exp_f32 v36, v36
    s_cselect_b32 s36, 0x100000, 0
    v_exp_f32 v37, v37
    v_add_u32 v5, s36, v4
    v_exp_f32 v38, v38
    v_exp_f32 v39, v39
    s_waitcnt vmcnt(12)
    v_cvt_pk_bf16_f32 v56, v32, v33
    v_cvt_pk_bf16_f32 v57, v34, v35
    v_mfma_f32_32x32x16_bf16 v[64:79], a[8:11], v[48:51], v[64:79]
    v_exp_f32 v40, v40
    v_exp_f32 v41, v41
    v_exp_f32 v42, v42
    v_exp_f32 v43, v43
    v_cvt_pk_bf16_f32 v58, v36, v37
    v_cvt_pk_bf16_f32 v59, v38, v39
    v_mfma_f32_32x32x16_bf16 v[64:79], a[12:15], v[52:55], v[64:79]
    v_exp_f32 v44, v44
    v_exp_f32 v45, v45
    v_exp_f32 v46, v46
    v_exp_f32 v47, v47
    v_cvt_pk_bf16_f32 v60, v40, v41
    v_cvt_pk_bf16_f32 v61, v42, v43
    v_cvt_pk_bf16_f32 v62, v44, v45
    v_cvt_pk_bf16_f32 v63, v46, v47
    v_mfma_f32_32x32x16_bf16 v[32:47], a[0:3], a[88:91], 0
    v_exp_f32 v16, v16
    v_exp_f32 v17, v17
    v_exp_f32 v18, v18
    v_exp_f32 v19, v19
    v_mfma_f32_32x32x16_bf16 v[32:47], a[4:7], a[92:95], v[32:47]
    buffer_load_dwordx4 a[0:3], v5, s[12:15], s44 offen sc1
    v_exp_f32 v20, v20
    v_exp_f32 v21, v21
    v_exp_f32 v22, v22
    v_exp_f32 v23, v23
    v_cvt_pk_bf16_f32 v48, v16, v17
    v_cvt_pk_bf16_f32 v49, v18, v19
    v_mfma_f32_32x32x16_bf16 v[80:95], a[8:11], v[56:59], v[80:95]
    buffer_load_dwordx4 a[4:7], v5, s[12:15], s44 offen offset:1024 sc1
    v_exp_f32 v24, v24
    v_exp_f32 v25, v25
    v_exp_f32 v26, v26
    v_exp_f32 v27, v27
    v_cvt_pk_bf16_f32 v50, v20, v21
    v_cvt_pk_bf16_f32 v51, v22, v23
    v_mfma_f32_32x32x16_bf16 v[80:95], a[12:15], v[60:63], v[80:95]
    v_exp_f32 v28, v28
    v_exp_f32 v29, v29
    v_exp_f32 v30, v30
    v_exp_f32 v31, v31
    s_waitcnt vmcnt(12)
    v_cvt_pk_bf16_f32 v52, v24, v25
    v_cvt_pk_bf16_f32 v53, v26, v27
    v_cvt_pk_bf16_f32 v54, v28, v29
    v_cvt_pk_bf16_f32 v55, v30, v31
    v_mfma_f32_32x32x16_bf16 v[16:31], a[16:19], a[64:67], 0
    v_exp_f32 v32, v32
    v_exp_f32 v33, v33
    v_exp_f32 v34, v34
    v_exp_f32 v35, v35
    v_mfma_f32_32x32x16_bf16 v[16:31], a[20:23], a[68:71], v[16:31]
    v_exp_f32 v36, v36
    v_exp_f32 v37, v37
    v_exp_f32 v38, v38
    v_exp_f32 v39, v39
    v_cvt_pk_bf16_f32 v56, v32, v33
    v_cvt_pk_bf16_f32 v57, v34, v35
    v_mfma_f32_32x32x16_bf16 v[96:111], a[8:11], v[48:51], v[96:111]
    v_exp_f32 v40, v40
    v_exp_f32 v41, v41
    v_exp_f32 v42, v42
    v_exp_f32 v43, v43
    v_cvt_pk_bf16_f32 v58, v36, v37
    v_cvt_pk_bf16_f32 v59, v38, v39
    v_mfma_f32_32x32x16_bf16 v[96:111], a[12:15], v[52:55], v[96:111]
    v_exp_f32 v44, v44
    v_exp_f32 v45, v45
    v_exp_f32 v46, v46
    v_exp_f32 v47, v47
    v_cvt_pk_bf16_f32 v60, v40, v41
    v_cvt_pk_bf16_f32 v61, v42, v43
    v_cvt_pk_bf16_f32 v62, v44, v45
    v_cvt_pk_bf16_f32 v63, v46, v47
    v_mfma_f32_32x32x16_bf16 v[32:47], a[16:19], a[72:75], 0
    v_exp_f32 v16, v16
    v_exp_f32 v17, v17
    v_exp_f32 v18, v18
    v_exp_f32 v19, v19
    v_mfma_f32_32x32x16_bf16 v[32:47], a[20:23], a[76:79], v[32:47]
    v_exp_f32 v20, v20
    v_exp_f32 v21, v21
    v_exp_f32 v22, v22
    v_exp_f32 v23, v23
    v_cvt_pk_bf16_f32 v48, v16, v17
    v_cvt_pk_bf16_f32 v49, v18, v19
    v_mfma_f32_32x32x16_bf16 v[112:127], a[8:11], v[56:59], v[112:127]
    v_exp_f32 v24, v24
    v_exp_f32 v25, v25
    v_exp_f32 v26, v26
    v_exp_f32 v27, v27
    v_cvt_pk_bf16_f32 v50, v20, v21
    v_cvt_pk_bf16_f32 v51, v22, v23
    v_mfma_f32_32x32x16_bf16 v[112:127], a[12:15], v[60:63], v[112:127]
    buffer_load_dwordx4 a[8:11], v5, s[12:15], s44 offen offset:2048 sc1
    v_exp_f32 v28, v28
    v_exp_f32 v29, v29
    v_exp_f32 v30, v30
    v_exp_f32 v31, v31
    buffer_load_dwordx4 a[12:15], v5, s[12:15], s44 offen offset:3072 sc1
    v_cvt_pk_bf16_f32 v52, v24, v25
    v_cvt_pk_bf16_f32 v53, v26, v27
    v_cvt_pk_bf16_f32 v54, v28, v29
    v_cvt_pk_bf16_f32 v55, v30, v31
    v_mfma_f32_32x32x16_bf16 v[16:31], a[16:19], a[80:83], 0
    v_exp_f32 v32, v32
    s_add_u32 s45, s45, 16384
    v_exp_f32 v33, v33
    v_exp_f32 v34, v34
    v_exp_f32 v35, v35
    v_mfma_f32_32x32x16_bf16 v[16:31], a[20:23], a[84:87], v[16:31]
    v_exp_f32 v36, v36
    v_exp_f32 v37, v37
    v_exp_f32 v38, v38
    v_exp_f32 v39, v39
    s_waitcnt vmcnt(12)
    v_cvt_pk_bf16_f32 v56, v32, v33
    v_cvt_pk_bf16_f32 v57, v34, v35
    v_mfma_f32_32x32x16_bf16 v[64:79], a[24:27], v[48:51], v[64:79]
    v_exp_f32 v40, v40
    v_exp_f32 v41, v41
    v_exp_f32 v42, v42
    v_exp_f32 v43, v43
    v_cvt_pk_bf16_f32 v58, v36, v37
    v_cvt_pk_bf16_f32 v59, v38, v39
    v_mfma_f32_32x32x16_bf16 v[64:79], a[28:31], v[52:55], v[64:79]
    v_exp_f32 v44, v44
    v_exp_f32 v45, v45
    v_exp_f32 v46, v46
    v_exp_f32 v47, v47
    v_cvt_pk_bf16_f32 v60, v40, v41
    v_cvt_pk_bf16_f32 v61, v42, v43
    v_cvt_pk_bf16_f32 v62, v44, v45
    v_cvt_pk_bf16_f32 v63, v46, v47
    v_mfma_f32_32x32x16_bf16 v[32:47], a[16:19], a[88:91], 0
    v_exp_f32 v16, v16
    v_exp_f32 v17, v17
    v_exp_f32 v18, v18
    v_exp_f32 v19, v19
    v_mfma_f32_32x32x16_bf16 v[32:47], a[20:23], a[92:95], v[32:47]
    buffer_load_dwordx4 a[16:19], v5, s[12:15], s45 offen sc1
    v_exp_f32 v20, v20
    v_exp_f32 v21, v21
    v_exp_f32 v22, v22
    v_exp_f32 v23, v23
    v_cvt_pk_bf16_f32 v48, v16, v17
    v_cvt_pk_bf16_f32 v49, v18, v19
    v_mfma_f32_32x32x16_bf16 v[80:95], a[24:27], v[56:59], v[80:95]
    buffer_load_dwordx4 a[20:23], v5, s[12:15], s45 offen offset:1024 sc1
    v_exp_f32 v24, v24
    v_exp_f32 v25, v25
    v_exp_f32 v26, v26
    v_exp_f32 v27, v27
    v_cvt_pk_bf16_f32 v50, v20, v21
    v_cvt_pk_bf16_f32 v51, v22, v23
    v_mfma_f32_32x32x16_bf16 v[80:95], a[28:31], v[60:63], v[80:95]
    v_exp_f32 v28, v28
    v_exp_f32 v29, v29
    v_exp_f32 v30, v30
    v_exp_f32 v31, v31
    s_waitcnt vmcnt(12)
    v_cvt_pk_bf16_f32 v52, v24, v25
    v_cvt_pk_bf16_f32 v53, v26, v27
    v_cvt_pk_bf16_f32 v54, v28, v29
    v_cvt_pk_bf16_f32 v55, v30, v31
    v_mfma_f32_32x32x16_bf16 v[16:31], a[32:35], a[64:67], 0
    v_exp_f32 v32, v32
    v_exp_f32 v33, v33
    v_exp_f32 v34, v34
    v_exp_f32 v35, v35
    v_mfma_f32_32x32x16_bf16 v[16:31], a[36:39], a[68:71], v[16:31]
    v_exp_f32 v36, v36
    v_exp_f32 v37, v37
    v_exp_f32 v38, v38
    v_exp_f32 v39, v39
    v_cvt_pk_bf16_f32 v56, v32, v33
    v_cvt_pk_bf16_f32 v57, v34, v35
    v_mfma_f32_32x32x16_bf16 v[96:111], a[24:27], v[48:51], v[96:111]
    v_exp_f32 v40, v40
    v_exp_f32 v41, v41
    v_exp_f32 v42, v42
    v_exp_f32 v43, v43
    v_cvt_pk_bf16_f32 v58, v36, v37
    v_cvt_pk_bf16_f32 v59, v38, v39
    v_mfma_f32_32x32x16_bf16 v[96:111], a[28:31], v[52:55], v[96:111]
    v_exp_f32 v44, v44
    v_exp_f32 v45, v45
    v_exp_f32 v46, v46
    v_exp_f32 v47, v47
    v_cvt_pk_bf16_f32 v60, v40, v41
    v_cvt_pk_bf16_f32 v61, v42, v43
    v_cvt_pk_bf16_f32 v62, v44, v45
    v_cvt_pk_bf16_f32 v63, v46, v47
    v_mfma_f32_32x32x16_bf16 v[32:47], a[32:35], a[72:75], 0
    v_exp_f32 v16, v16
    v_exp_f32 v17, v17
    v_exp_f32 v18, v18
    v_exp_f32 v19, v19
    v_mfma_f32_32x32x16_bf16 v[32:47], a[36:39], a[76:79], v[32:47]
    v_exp_f32 v20, v20
    v_exp_f32 v21, v21
    v_exp_f32 v22, v22
    v_exp_f32 v23, v23
    v_cvt_pk_bf16_f32 v48, v16, v17
    v_cvt_pk_bf16_f32 v49, v18, v19
    v_mfma_f32_32x32x16_bf16 v[112:127], a[24:27], v[56:59], v[112:127]
    v_exp_f32 v24, v24
    v_exp_f32 v25, v25
    v_exp_f32 v26, v26
    v_exp_f32 v27, v27
    v_cvt_pk_bf16_f32 v50, v20, v21
    v_cvt_pk_bf16_f32 v51, v22, v23
    v_mfma_f32_32x32x16_bf16 v[112:127], a[28:31], v[60:63], v[112:127]
    buffer_load_dwordx4 a[24:27], v5, s[12:15], s45 offen offset:2048 sc1
    v_exp_f32 v28, v28
    v_exp_f32 v29, v29
    v_exp_f32 v30, v30
    v_exp_f32 v31, v31
    buffer_load_dwordx4 a[28:31], v5, s[12:15], s45 offen offset:3072 sc1
    v_cvt_pk_bf16_f32 v52, v24, v25
    v_cvt_pk_bf16_f32 v53, v26, v27
    v_cvt_pk_bf16_f32 v54, v28, v29
    v_cvt_pk_bf16_f32 v55, v30, v31
    v_mfma_f32_32x32x16_bf16 v[16:31], a[32:35], a[80:83], 0
    v_exp_f32 v32, v32
    s_add_u32 s46, s46, 16384
    v_exp_f32 v33, v33
    v_exp_f32 v34, v34
    v_exp_f32 v35, v35
    v_mfma_f32_32x32x16_bf16 v[16:31], a[36:39], a[84:87], v[16:31]
    v_exp_f32 v36, v36
    v_exp_f32 v37, v37
    v_exp_f32 v38, v38
    v_exp_f32 v39, v39
    s_waitcnt vmcnt(12)
    v_cvt_pk_bf16_f32 v56, v32, v33
    v_cvt_pk_bf16_f32 v57, v34, v35
    v_mfma_f32_32x32x16_bf16 v[64:79], a[40:43], v[48:51], v[64:79]
    v_exp_f32 v40, v40
    v_exp_f32 v41, v41
    v_exp_f32 v42, v42
    v_exp_f32 v43, v43
    v_cvt_pk_bf16_f32 v58, v36, v37
    v_cvt_pk_bf16_f32 v59, v38, v39
    v_mfma_f32_32x32x16_bf16 v[64:79], a[44:47], v[52:55], v[64:79]
    v_exp_f32 v44, v44
    v_exp_f32 v45, v45
    v_exp_f32 v46, v46
    v_exp_f32 v47, v47
    v_cvt_pk_bf16_f32 v60, v40, v41
    v_cvt_pk_bf16_f32 v61, v42, v43
    v_cvt_pk_bf16_f32 v62, v44, v45
    v_cvt_pk_bf16_f32 v63, v46, v47
    v_mfma_f32_32x32x16_bf16 v[32:47], a[32:35], a[88:91], 0
    v_exp_f32 v16, v16
    v_exp_f32 v17, v17
    v_exp_f32 v18, v18
    v_exp_f32 v19, v19
    v_mfma_f32_32x32x16_bf16 v[32:47], a[36:39], a[92:95], v[32:47]
    buffer_load_dwordx4 a[32:35], v5, s[12:15], s46 offen sc1
    v_exp_f32 v20, v20
    v_exp_f32 v21, v21
    v_exp_f32 v22, v22
    v_exp_f32 v23, v23
    v_cvt_pk_bf16_f32 v48, v16, v17
    v_cvt_pk_bf16_f32 v49, v18, v19
    v_mfma_f32_32x32x16_bf16 v[80:95], a[40:43], v[56:59], v[80:95]
    buffer_load_dwordx4 a[36:39], v5, s[12:15], s46 offen offset:1024 sc1
    v_exp_f32 v24, v24
    v_exp_f32 v25, v25
    v_exp_f32 v26, v26
    v_exp_f32 v27, v27
    v_cvt_pk_bf16_f32 v50, v20, v21
    v_cvt_pk_bf16_f32 v51, v22, v23
    v_mfma_f32_32x32x16_bf16 v[80:95], a[44:47], v[60:63], v[80:95]
    v_exp_f32 v28, v28
    v_exp_f32 v29, v29
    v_exp_f32 v30, v30
    v_exp_f32 v31, v31
    s_waitcnt vmcnt(12)
    v_cvt_pk_bf16_f32 v52, v24, v25
    v_cvt_pk_bf16_f32 v53, v26, v27
    v_cvt_pk_bf16_f32 v54, v28, v29
    v_cvt_pk_bf16_f32 v55, v30, v31
    v_mfma_f32_32x32x16_bf16 v[16:31], a[48:51], a[64:67], 0
    v_exp_f32 v32, v32
    v_exp_f32 v33, v33
    v_exp_f32 v34, v34
    v_exp_f32 v35, v35
    v_mfma_f32_32x32x16_bf16 v[16:31], a[52:55], a[68:71], v[16:31]
    v_exp_f32 v36, v36
    v_exp_f32 v37, v37
    v_exp_f32 v38, v38
    v_exp_f32 v39, v39
    v_cvt_pk_bf16_f32 v56, v32, v33
    v_cvt_pk_bf16_f32 v57, v34, v35
    v_mfma_f32_32x32x16_bf16 v[96:111], a[40:43], v[48:51], v[96:111]
    v_exp_f32 v40, v40
    v_exp_f32 v41, v41
    v_exp_f32 v42, v42
    v_exp_f32 v43, v43
    v_cvt_pk_bf16_f32 v58, v36, v37
    v_cvt_pk_bf16_f32 v59, v38, v39
    v_mfma_f32_32x32x16_bf16 v[96:111], a[44:47], v[52:55], v[96:111]
    v_exp_f32 v44, v44
    v_exp_f32 v45, v45
    v_exp_f32 v46, v46
    v_exp_f32 v47, v47
    v_cvt_pk_bf16_f32 v60, v40, v41
    v_cvt_pk_bf16_f32 v61, v42, v43
    v_cvt_pk_bf16_f32 v62, v44, v45
    v_cvt_pk_bf16_f32 v63, v46, v47
    v_mfma_f32_32x32x16_bf16 v[32:47], a[48:51], a[72:75], 0
    v_exp_f32 v16, v16
    v_exp_f32 v17, v17
    v_exp_f32 v18, v18
    v_exp_f32 v19, v19
    v_mfma_f32_32x32x16_bf16 v[32:47], a[52:55], a[76:79], v[32:47]
    v_exp_f32 v20, v20
    v_exp_f32 v21, v21
    v_exp_f32 v22, v22
    v_exp_f32 v23, v23
    v_cvt_pk_bf16_f32 v48, v16, v17
    v_cvt_pk_bf16_f32 v49, v18, v19
    v_mfma_f32_32x32x16_bf16 v[112:127], a[40:43], v[56:59], v[112:127]
    v_exp_f32 v24, v24
    v_exp_f32 v25, v25
    v_exp_f32 v26, v26
    v_exp_f32 v27, v27
    v_cvt_pk_bf16_f32 v50, v20, v21
    v_cvt_pk_bf16_f32 v51, v22, v23
    v_mfma_f32_32x32x16_bf16 v[112:127], a[44:47], v[60:63], v[112:127]
    buffer_load_dwordx4 a[40:43], v5, s[12:15], s46 offen offset:2048 sc1
    v_exp_f32 v28, v28
    v_exp_f32 v29, v29
    v_exp_f32 v30, v30
    v_exp_f32 v31, v31
    buffer_load_dwordx4 a[44:47], v5, s[12:15], s46 offen offset:3072 sc1
    v_cvt_pk_bf16_f32 v52, v24, v25
    v_cvt_pk_bf16_f32 v53, v26, v27
    v_cvt_pk_bf16_f32 v54, v28, v29
    v_cvt_pk_bf16_f32 v55, v30, v31
    v_mfma_f32_32x32x16_bf16 v[16:31], a[48:51], a[80:83], 0
    v_exp_f32 v32, v32
    s_add_u32 s47, s47, 16384
    v_exp_f32 v33, v33
    v_exp_f32 v34, v34
    s_sub_u32 s35, s35, 1
    v_exp_f32 v35, v35
    v_mfma_f32_32x32x16_bf16 v[16:31], a[52:55], a[84:87], v[16:31]
    v_exp_f32 v36, v36
    v_exp_f32 v37, v37
    v_exp_f32 v38, v38
    v_exp_f32 v39, v39
    s_waitcnt vmcnt(12)
    v_cvt_pk_bf16_f32 v56, v32, v33
    v_cvt_pk_bf16_f32 v57, v34, v35
    v_mfma_f32_32x32x16_bf16 v[64:79], a[56:59], v[48:51], v[64:79]
    v_exp_f32 v40, v40
    v_exp_f32 v41, v41
    v_exp_f32 v42, v42
    v_exp_f32 v43, v43
    v_cvt_pk_bf16_f32 v58, v36, v37
    v_cvt_pk_bf16_f32 v59, v38, v39
    v_mfma_f32_32x32x16_bf16 v[64:79], a[60:63], v[52:55], v[64:79]
    v_exp_f32 v44, v44
    v_exp_f32 v45, v45
    v_exp_f32 v46, v46
    v_exp_f32 v47, v47
    v_cvt_pk_bf16_f32 v60, v40, v41
    v_cvt_pk_bf16_f32 v61, v42, v43
    v_cvt_pk_bf16_f32 v62, v44, v45
    v_cvt_pk_bf16_f32 v63, v46, v47
    v_mfma_f32_32x32x16_bf16 v[32:47], a[48:51], a[88:91], 0
    v_exp_f32 v16, v16
    v_exp_f32 v17, v17
    v_exp_f32 v18, v18
    v_exp_f32 v19, v19
    v_mfma_f32_32x32x16_bf16 v[32:47], a[52:55], a[92:95], v[32:47]
    buffer_load_dwordx4 a[48:51], v5, s[12:15], s47 offen sc1
    v_exp_f32 v20, v20
    v_exp_f32 v21, v21
    v_exp_f32 v22, v22
    v_exp_f32 v23, v23
    v_cvt_pk_bf16_f32 v48, v16, v17
    v_cvt_pk_bf16_f32 v49, v18, v19
    v_mfma_f32_32x32x16_bf16 v[80:95], a[56:59], v[56:59], v[80:95]
    buffer_load_dwordx4 a[52:55], v5, s[12:15], s47 offen offset:1024 sc1
    v_exp_f32 v24, v24
    v_exp_f32 v25, v25
    v_exp_f32 v26, v26
    v_exp_f32 v27, v27
    v_cvt_pk_bf16_f32 v50, v20, v21
    v_cvt_pk_bf16_f32 v51, v22, v23
    v_mfma_f32_32x32x16_bf16 v[80:95], a[60:63], v[60:63], v[80:95]
    v_exp_f32 v28, v28
    v_exp_f32 v29, v29
    v_exp_f32 v30, v30
    v_exp_f32 v31, v31
    s_waitcnt vmcnt(12)
    v_cvt_pk_bf16_f32 v52, v24, v25
    v_cvt_pk_bf16_f32 v53, v26, v27
    v_cvt_pk_bf16_f32 v54, v28, v29
    v_cvt_pk_bf16_f32 v55, v30, v31
    v_mfma_f32_32x32x16_bf16 v[16:31], a[0:3], a[64:67], 0
    v_exp_f32 v32, v32
    v_exp_f32 v33, v33
    v_exp_f32 v34, v34
    v_exp_f32 v35, v35
    v_mfma_f32_32x32x16_bf16 v[16:31], a[4:7], a[68:71], v[16:31]
    v_exp_f32 v36, v36
    v_exp_f32 v37, v37
    v_exp_f32 v38, v38
    v_exp_f32 v39, v39
    v_cvt_pk_bf16_f32 v56, v32, v33
    v_cvt_pk_bf16_f32 v57, v34, v35
    v_mfma_f32_32x32x16_bf16 v[96:111], a[56:59], v[48:51], v[96:111]
    v_exp_f32 v40, v40
    v_exp_f32 v41, v41
    v_exp_f32 v42, v42
    v_exp_f32 v43, v43
    v_cvt_pk_bf16_f32 v58, v36, v37
    v_cvt_pk_bf16_f32 v59, v38, v39
    v_mfma_f32_32x32x16_bf16 v[96:111], a[60:63], v[52:55], v[96:111]
    v_exp_f32 v44, v44
    v_exp_f32 v45, v45
    v_exp_f32 v46, v46
    s_cmp_lg_u32 s35, 0
    v_exp_f32 v47, v47
    v_cvt_pk_bf16_f32 v60, v40, v41
    v_cvt_pk_bf16_f32 v61, v42, v43
    v_cvt_pk_bf16_f32 v62, v44, v45
    v_cvt_pk_bf16_f32 v63, v46, v47
    s_cbranch_scc1 P2_LOOP
    v_mfma_f32_32x32x16_bf16 v[112:127], a[56:59], v[56:59], v[112:127]
    v_mfma_f32_32x32x16_bf16 v[112:127], a[60:63], v[60:63], v[112:127]
    s_mul_i32 s33, s41, 12288
    s_add_u32 s33, s33, 114688
    v_add_u32 v6, s33, v4
    s_mul_i32 s33, s42, 12288
    s_add_u32 s33, s33, 118784
    v_add_u32 v7, s33, v4
    s_mul_i32 s33, s43, 12288
    s_add_u32 s33, s33, 122880
    v_add_u32 v8, s33, v4
    ds_write_b128 v6, v[80:83] offset:0
    ds_write_b128 v6, v[84:87] offset:1024
    ds_write_b128 v6, v[88:91] offset:2048
    ds_write_b128 v6, v[92:95] offset:3072
    ds_write_b128 v7, v[96:99] offset:0
    ds_write_b128 v7, v[100:103] offset:1024
    ds_write_b128 v7, v[104:107] offset:2048
    ds_write_b128 v7, v[108:111] offset:3072
    s_mul_i32 s33, s62, 12288
    s_add_u32 s33, s33, 114688
    v_add_u32 v5, s33, v4
    ds_write_b128 v8, v[112:115] offset:0
    ds_write_b128 v8, v[116:119] offset:1024
    ds_write_b128 v8, v[120:123] offset:2048
    ds_write_b128 v8, v[124:127] offset:3072
    s_waitcnt lgkmcnt(0)
    s_barrier
    ds_read_b128 v[16:19], v5 offset:0
    ds_read_b128 v[20:23], v5 offset:1024
    ds_read_b128 v[24:27], v5 offset:2048
    ds_read_b128 v[28:31], v5 offset:3072
    ds_read_b128 v[32:35], v5 offset:4096
    ds_read_b128 v[36:39], v5 offset:5120
    ds_read_b128 v[40:43], v5 offset:6144
    ds_read_b128 v[44:47], v5 offset:7168
    ds_read_b128 v[48:51], v5 offset:8192
    ds_read_b128 v[52:55], v5 offset:9216
    ds_read_b128 v[56:59], v5 offset:10240
    ds_read_b128 v[60:63], v5 offset:11264
    s_waitcnt lgkmcnt(11)
    v_pk_add_f32 v[64:65], v[64:65], v[16:17]
    v_pk_add_f32 v[66:67], v[66:67], v[18:19]
    s_waitcnt lgkmcnt(10)
    v_pk_add_f32 v[68:69], v[68:69], v[20:21]
    v_pk_add_f32 v[70:71], v[70:71], v[22:23]
    s_waitcnt lgkmcnt(9)
    v_pk_add_f32 v[72:73], v[72:73], v[24:25]
    v_pk_add_f32 v[74:75], v[74:75], v[26:27]
    s_waitcnt lgkmcnt(8)
    v_pk_add_f32 v[76:77], v[76:77], v[28:29]
    v_pk_add_f32 v[78:79], v[78:79], v[30:31]
    s_waitcnt lgkmcnt(7)
    v_pk_add_f32 v[64:65], v[64:65], v[32:33]
    v_pk_add_f32 v[66:67], v[66:67], v[34:35]
    s_waitcnt lgkmcnt(6)
    v_pk_add_f32 v[68:69], v[68:69], v[36:37]
    v_pk_add_f32 v[70:71], v[70:71], v[38:39]
    s_waitcnt lgkmcnt(5)
    v_pk_add_f32 v[72:73], v[72:73], v[40:41]
    v_pk_add_f32 v[74:75], v[74:75], v[42:43]
    s_waitcnt lgkmcnt(4)
    v_pk_add_f32 v[76:77], v[76:77], v[44:45]
    v_pk_add_f32 v[78:79], v[78:79], v[46:47]
    s_waitcnt lgkmcnt(3)
    v_pk_add_f32 v[64:65], v[64:65], v[48:49]
    v_pk_add_f32 v[66:67], v[66:67], v[50:51]
    s_waitcnt lgkmcnt(2)
    v_pk_add_f32 v[68:69], v[68:69], v[52:53]
    v_pk_add_f32 v[70:71], v[70:71], v[54:55]
    s_waitcnt lgkmcnt(1)
    v_pk_add_f32 v[72:73], v[72:73], v[56:57]
    v_pk_add_f32 v[74:75], v[74:75], v[58:59]
    s_waitcnt lgkmcnt(0)
    s_barrier
    v_pk_add_f32 v[76:77], v[76:77], v[60:61]
    v_pk_add_f32 v[78:79], v[78:79], v[62:63]
    v_mov_b32 v8, 0
    v_mov_b32 v9, 0
    v_mov_b32 v10, 0
    v_mov_b32 v11, 0
    v_pk_fma_f32 v[8:9], v[64:65], v[10:11], v[8:9]
    v_pk_fma_f32 v[8:9], v[66:67], v[10:11], v[8:9]
    v_pk_fma_f32 v[8:9], v[68:69], v[10:11], v[8:9]
    v_pk_fma_f32 v[8:9], v[70:71], v[10:11], v[8:9]
    v_pk_fma_f32 v[8:9], v[72:73], v[10:11], v[8:9]
    v_pk_fma_f32 v[8:9], v[74:75], v[10:11], v[8:9]
    v_pk_fma_f32 v[8:9], v[76:77], v[10:11], v[8:9]
    v_pk_fma_f32 v[8:9], v[78:79], v[10:11], v[8:9]
    v_mov_b32 v10, 0x7b800000
    v_cmp_u_f32 vcc, v8, v9
    v_cmp_nlt_f32 s[44:45], v76, v10
    s_nop 0
    s_or_b32 s44, s45, vcc_lo
    s_or_b32 s44, s44, vcc_hi
    s_cmp_lg_u32 s44, 0
    s_cbranch_scc1 P2_SLOW
P2_FIN:
    v_mov_b32 v8, v76
    v_mov_b32 v10, v76
    s_nop 1
    v_permlane32_swap_b32 v8, v10
    v_rcp_f32 v10, v10
    s_nop 0
    v_pk_mul_f32 v[64:65], v[64:65], v[10:11] op_sel_hi:[1,0]
    v_pk_mul_f32 v[66:67], v[66:67], v[10:11] op_sel_hi:[1,0]
    v_pk_mul_f32 v[68:69], v[68:69], v[10:11] op_sel_hi:[1,0]
    v_pk_mul_f32 v[70:71], v[70:71], v[10:11] op_sel_hi:[1,0]
    v_pk_mul_f32 v[72:73], v[72:73], v[10:11] op_sel_hi:[1,0]
    v_pk_mul_f32 v[74:75], v[74:75], v[10:11] op_sel_hi:[1,0]
    v_pk_mul_f32 v[76:77], v[76:77], v[10:11] op_sel_hi:[1,0]
    v_pk_mul_f32 v[78:79], v[78:79], v[10:11] op_sel_hi:[1,0]
    v_cvt_pk_bf16_f32 v96, v64, v65
    v_cvt_pk_bf16_f32 v97, v66, v67
    v_cvt_pk_bf16_f32 v98, v68, v69
    v_cvt_pk_bf16_f32 v99, v70, v71
    v_cvt_pk_bf16_f32 v100, v72, v73
    v_cvt_pk_bf16_f32 v101, v74, v75
    v_cvt_pk_bf16_f32 v102, v76, v77
    v_cvt_pk_bf16_f32 v103, v78, v79
    s_mov_b32 exec_lo, 0
    s_mov_b32 exec_hi, -1
    v_mov_b32 v102, 0
    v_mov_b32 v103, 0
    s_mov_b64 exec, -1
    buffer_store_dwordx4 v[96:99], v4, s[8:11], s38 offen offset:0 sc0 sc1
    buffer_store_dwordx4 v[100:103], v4, s[8:11], s38 offen offset:1024 sc0 sc1
    s_setprio 0
    s_and_b32 s3, s2, 7
    s_lshr_b32 s49, s2, 3
    s_mul_i32 s50, s49, 37
    s_lshr_b32 s50, s50, 8
    s_mul_i32 s51, s50, 7
    s_sub_u32 s51, s49, s51
    s_lshl_b32 s51, s51, 7
    s_lshl_b32 s3, s3, 2
    s_add_u32 s50, s50, s3
    s_and_b32 s50, s50, 31
    s_and_b32 s52, s23, 1
    s_lshl_b32 s3, s50, 1
    s_add_u32 s52, s52, s3
    s_lshr_b32 s53, s23, 1
    v_bfe_u32 v6, v1, 2, 2
    v_lshrrev_b32 v7, 5, v1
    v_lshl_add_u32 v8, v7, 2, v6
    v_lshlrev_b32 v5, 7, v8
    s_and_b32 s54, s53, 1
    s_lshr_b32 s55, s53, 1
    v_bfe_u32 v8, v1, 4, 1
    v_xor_b32 v8, s54, v8
    v_lshl_add_u32 v5, v8, 5, v5
    v_and_b32 v8, 1, v1
    v_lshl_add_u32 v5, v8, 4, v5
    v_bfe_u32 v8, v1, 1, 1
    v_lshl_add_u32 v5, v8, 3, v5
    s_mul_i32 s56, s53, 14336
    v_add_u32 v5, s56, v5
    v_lshrrev_b32 v6, 1, v6
    v_xor_b32 v6, s55, v6
    v_lshl_add_u32 v131, v6, 6, v5
    v_xor_b32 v6, 1, v6
    v_lshl_add_u32 v132, v6, 6, v5
    v_lshlrev_b32 v9, 9, v7
    v_sub_u32 v133, v131, v9
    v_sub_u32 v134, v132, v9
    s_and_b32 s56, s23, 1
    s_mul_i32 s56, s56, 24576
    s_add_u32 s56, s56, 114688
    s_xor_b32 s57, s53, 1
    s_mul_i32 s57, s57, 6144
    s_add_u32 s57, s57, s56
    s_add_u32 s57, s57, 0
    v_add_u32 v135, s57, v4
    s_xor_b32 s57, s53, 2
    s_mul_i32 s57, s57, 6144
    s_add_u32 s57, s57, s56
    s_add_u32 s57, s57, 2048
    v_add_u32 v136, s57, v4
    s_xor_b32 s57, s53, 3
    s_mul_i32 s57, s57, 6144
    s_add_u32 s57, s57, s56
    s_add_u32 s57, s57, 4096
    v_add_u32 v137, s57, v4
    s_mul_i32 s57, s53, 6144
    s_add_u32 s57, s57, s56
    v_add_u32 v138, s57, v4
    v_and_b32 v8, 31, v1
    v_mul_u32_u24 v8, 1792, v8
    v_lshl_add_u32 v139, v7, 4, v8
    s_mul_i32 s58, s52, 57344
    s_add_u32 s58, s58, s51
    s_lshl_b32 s57, s53, 5
    s_add_u32 s58, s58, s57
    s_add_u32 s59, s58, 896
    s_mov_b32 s16, s92
    s_and_b32 s17, s93, 0xffff
    s_mov_b32 s18, 3670016
    s_mov_b32 s19, 0x20000
    s_add_u32 s29, s52, 64
    s_lshl_b32 s29, s29, 4
    s_lshl_b32 s28, s53, 2
    s_add_u32 s29, s29, s28
    s_lshl_b32 s29, s29, 11
    s_add_u32 s29, s29, 12582912
    s_add_u32 s30, s29, 4096
    s_waitcnt vmcnt(0)
    s_barrier
    s_cmp_lg_u32 s23, 0
    s_cbranch_scc1 P3_NOFL
    v_mov_b32 v128, s60
    v_mov_b32 v129, s61
    v_lshlrev_b32 v130, 3, v1
    s_mov_b32 exec_lo, 1
    s_mov_b32 exec_hi, 0
    buffer_store_dwordx2 v[128:129], v130, s[8:11], s39 offen sc1
    s_mov_b64 exec, -1
P3_NOFL:
    s_cmp_ge_u32 s2, 224
    s_cbranch_scc1 KF_FIN
    buffer_load_dwordx4 a[0:3], v4, s[8:11], s29 offen offset:0 sc1
    buffer_load_dwordx4 a[4:7], v4, s[8:11], s29 offen offset:1024 sc1
    buffer_load_dwordx4 a[8:11], v4, s[8:11], s29 offen offset:2048 sc1
    buffer_load_dwordx4 a[12:15], v4, s[8:11], s29 offen offset:3072 sc1
    buffer_load_dwordx4 a[16:19], v4, s[8:11], s30 offen offset:0 sc1
    buffer_load_dwordx4 a[20:23], v4, s[8:11], s30 offen offset:1024 sc1
    buffer_load_dwordx4 a[24:27], v4, s[8:11], s30 offen offset:2048 sc1
    buffer_load_dwordx4 a[28:31], v4, s[8:11], s30 offen offset:3072 sc1
P3B:
    ds_read_b64_tr_b16 v[48:49], v131 offset:0
    ds_read_b64_tr_b16 v[50:51], v131 offset:1024
    ds_read_b64_tr_b16 v[52:53], v132 offset:0
    ds_read_b64_tr_b16 v[54:55], v132 offset:1024
    ds_read_b64_tr_b16 v[56:57], v131 offset:2048
    ds_read_b64_tr_b16 v[58:59], v133 offset:3072
    ds_read_b64_tr_b16 v[60:61], v132 offset:2048
    ds_read_b64_tr_b16 v[62:63], v134 offset:3072
    ds_read_b64_tr_b16 v[64:65], v131 offset:3584
    ds_read_b64_tr_b16 v[66:67], v131 offset:4608
    ds_read_b64_tr_b16 v[68:69], v132 offset:3584
    ds_read_b64_tr_b16 v[70:71], v132 offset:4608
    s_waitcnt vmcnt(7)
    s_waitcnt lgkmcnt(10)
    v_mfma_f32_32x32x16_bf16 v[16:31], v[48:51], a[0:3], 0
    ds_read_b64_tr_b16 v[72:73], v131 offset:5632
    ds_read_b64_tr_b16 v[74:75], v133 offset:6656
    s_waitcnt lgkmcnt(10)
    v_mfma_f32_32x32x16_bf16 v[32:47], v[52:55], a[0:3], 0
    ds_read_b64_tr_b16 v[76:77], v132 offset:5632
    ds_read_b64_tr_b16 v[78:79], v134 offset:6656
    s_waitcnt vmcnt(6)
    s_waitcnt lgkmcnt(10)
    v_mfma_f32_32x32x16_bf16 v[16:31], v[56:59], a[4:7], v[16:31]
    ds_read_b64_tr_b16 v[48:49], v131 offset:7168
    ds_read_b64_tr_b16 v[50:51], v131 offset:8192
    s_waitcnt lgkmcnt(10)
    v_mfma_f32_32x32x16_bf16 v[32:47], v[60:63], a[4:7], v[32:47]
    ds_read_b64_tr_b16 v[52:53], v132 offset:7168
    ds_read_b64_tr_b16 v[54:55], v132 offset:8192
    s_waitcnt vmcnt(5)
    s_waitcnt lgkmcnt(10)
    v_mfma_f32_32x32x16_bf16 v[16:31], v[64:67], a[8:11], v[16:31]
    ds_read_b64_tr_b16 v[56:57], v131 offset:9216
    ds_read_b64_tr_b16 v[58:59], v133 offset:10240
    s_waitcnt lgkmcnt(10)
    v_mfma_f32_32x32x16_bf16 v[32:47], v[68:71], a[8:11], v[32:47]
    ds_read_b64_tr_b16 v[60:61], v132 offset:9216
    ds_read_b64_tr_b16 v[62:63], v134 offset:10240
    s_waitcnt vmcnt(4)
    s_waitcnt lgkmcnt(10)
    v_mfma_f32_32x32x16_bf16 v[16:31], v[72:75], a[12:15], v[16:31]
    ds_read_b64_tr_b16 v[64:65], v131 offset:10752
    ds_read_b64_tr_b16 v[66:67], v131 offset:11776
    s_waitcnt lgkmcnt(10)
    v_mfma_f32_32x32x16_bf16 v[32:47], v[76:79], a[12:15], v[32:47]
    ds_read_b64_tr_b16 v[68:69], v132 offset:10752
    ds_read_b64_tr_b16 v[70:71], v132 offset:11776
    s_waitcnt vmcnt(3)
    s_waitcnt lgkmcnt(10)
    v_mfma_f32_32x32x16_bf16 v[16:31], v[48:51], a[16:19], v[16:31]
    ds_read_b64_tr_b16 v[72:73], v131 offset:12800
    ds_read_b64_tr_b16 v[74:75], v133 offset:13824
    s_waitcnt lgkmcnt(10)
    v_mfma_f32_32x32x16_bf16 v[32:47], v[52:55], a[16:19], v[32:47]
    ds_read_b64_tr_b16 v[76:77], v132 offset:12800
    ds_read_b64_tr_b16 v[78:79], v134 offset:13824
    s_waitcnt vmcnt(2)
    s_waitcnt lgkmcnt(10)
    v_mfma_f32_32x32x16_bf16 v[16:31], v[56:59], a[20:23], v[16:31]
    s_waitcnt lgkmcnt(8)
    v_mfma_f32_32x32x16_bf16 v[32:47], v[60:63], a[20:23], v[32:47]
    s_waitcnt vmcnt(1)
    s_waitcnt lgkmcnt(6)
    v_mfma_f32_32x32x16_bf16 v[16:31], v[64:67], a[24:27], v[16:31]
    s_waitcnt lgkmcnt(4)
    v_mfma_f32_32x32x16_bf16 v[32:47], v[68:71], a[24:27], v[32:47]
    s_waitcnt vmcnt(0)
    s_waitcnt lgkmcnt(2)
    v_mfma_f32_32x32x16_bf16 v[16:31], v[72:75], a[28:31], v[16:31]
    s_waitcnt lgkmcnt(0)
    v_mfma_f32_32x32x16_bf16 v[32:47], v[76:79], a[28:31], v[32:47]
    s_nop 9
    ds_write_b128 v135, v[24:27]
    ds_write_b128 v135, v[28:31] offset:1024
    ds_write_b128 v136, v[32:35]
    ds_write_b128 v136, v[36:39] offset:1024
    ds_write_b128 v137, v[40:43]
    ds_write_b128 v137, v[44:47] offset:1024
    s_waitcnt lgkmcnt(0)
    s_barrier
    ds_read_b128 v[80:83], v138 offset:0
    ds_read_b128 v[84:87], v138 offset:1024
    ds_read_b128 v[88:91], v138 offset:2048
    ds_read_b128 v[92:95], v138 offset:3072
    ds_read_b128 v[96:99], v138 offset:4096
    ds_read_b128 v[100:103], v138 offset:5120
    s_waitcnt lgkmcnt(4)
    v_pk_add_f32 v[16:17], v[16:17], v[80:81]
    v_pk_add_f32 v[18:19], v[18:19], v[82:83]
    v_pk_add_f32 v[20:21], v[20:21], v[84:85]
    v_pk_add_f32 v[22:23], v[22:23], v[86:87]
    s_waitcnt lgkmcnt(2)
    v_pk_add_f32 v[16:17], v[16:17], v[88:89]
    v_pk_add_f32 v[18:19], v[18:19], v[90:91]
    v_pk_add_f32 v[20:21], v[20:21], v[92:93]
    v_pk_add_f32 v[22:23], v[22:23], v[94:95]
    s_waitcnt lgkmcnt(0)
    v_pk_add_f32 v[16:17], v[16:17], v[96:97]
    v_pk_add_f32 v[18:19], v[18:19], v[98:99]
    v_pk_add_f32 v[20:21], v[20:21], v[100:101]
    v_pk_add_f32 v[22:23], v[22:23], v[102:103]
    v_cvt_pk_bf16_f32 v104, v16, v17
    v_cvt_pk_bf16_f32 v105, v18, v19
    v_cvt_pk_bf16_f32 v106, v20, v21
    v_cvt_pk_bf16_f32 v107, v22, v23
    buffer_store_dwordx4 v[104:107], v139, s[16:19], s59 offen sc0 sc1
    v_add_u32 v131, 57344, v131
    v_add_u32 v132, 57344, v132
    v_add_u32 v133, 57344, v133
    v_add_u32 v134, 57344, v134
    ds_read_b64_tr_b16 v[48:49], v131 offset:0
    ds_read_b64_tr_b16 v[50:51], v131 offset:1024
    ds_read_b64_tr_b16 v[52:53], v132 offset:0
    ds_read_b64_tr_b16 v[54:55], v132 offset:1024
    ds_read_b64_tr_b16 v[56:57], v131 offset:2048
    ds_read_b64_tr_b16 v[58:59], v133 offset:3072
    ds_read_b64_tr_b16 v[60:61], v132 offset:2048
    ds_read_b64_tr_b16 v[62:63], v134 offset:3072
    ds_read_b64_tr_b16 v[64:65], v131 offset:3584
    ds_read_b64_tr_b16 v[66:67], v131 offset:4608
    ds_read_b64_tr_b16 v[68:69], v132 offset:3584
    ds_read_b64_tr_b16 v[70:71], v132 offset:4608
    s_add_u32 s29, s52, 0
    s_lshl_b32 s29, s29, 4
    s_lshl_b32 s28, s53, 2
    s_add_u32 s29, s29, s28
    s_lshl_b32 s29, s29, 11
    s_add_u32 s29, s29, 12582912
    s_add_u32 s30, s29, 4096
    s_cmp_lg_u32 s23, 4
    s_cbranch_scc1 P3_X2
    s_lshr_b32 s34, s50, 1
    s_lshl_b32 s34, s34, 7
    s_add_u32 s34, s34, 16781312
    v_and_b32 v130, 15, v1
    v_lshlrev_b32 v130, 3, v130
    buffer_load_dwordx2 v[128:129], v130, s[8:11], s34 offen sc1
    s_mov_b32 s63, 0
POLL23:
    s_waitcnt vmcnt(0)
    v_cmp_ne_u64 vcc, s[60:61], v[128:129]
    s_nop 1
    s_cbranch_vccz POLL_OK23
    s_add_u32 s63, s63, 1
    s_cmp_gt_u32 s63, 131072
    s_cbranch_scc1 KERNEL_END
    s_sleep 2
    buffer_load_dwordx2 v[128:129], v130, s[8:11], s34 offen sc1
    s_branch POLL23
POLL_OK23:
P3_X2:
    s_barrier
    buffer_load_dwordx4 a[0:3], v4, s[8:11], s29 offen offset:0 sc1
    buffer_load_dwordx4 a[4:7], v4, s[8:11], s29 offen offset:1024 sc1
    buffer_load_dwordx4 a[8:11], v4, s[8:11], s29 offen offset:2048 sc1
    buffer_load_dwordx4 a[12:15], v4, s[8:11], s29 offen offset:3072 sc1
    buffer_load_dwordx4 a[16:19], v4, s[8:11], s30 offen offset:0 sc1
    buffer_load_dwordx4 a[20:23], v4, s[8:11], s30 offen offset:1024 sc1
    buffer_load_dwordx4 a[24:27], v4, s[8:11], s30 offen offset:2048 sc1
    buffer_load_dwordx4 a[28:31], v4, s[8:11], s30 offen offset:3072 sc1
    s_waitcnt vmcnt(7)
    s_waitcnt lgkmcnt(10)
    v_mfma_f32_32x32x16_bf16 v[16:31], v[48:51], a[0:3], 0
    ds_read_b64_tr_b16 v[72:73], v131 offset:5632
    ds_read_b64_tr_b16 v[74:75], v133 offset:6656
    s_waitcnt lgkmcnt(10)
    v_mfma_f32_32x32x16_bf16 v[32:47], v[52:55], a[0:3], 0
    ds_read_b64_tr_b16 v[76:77], v132 offset:5632
    ds_read_b64_tr_b16 v[78:79], v134 offset:6656
    s_waitcnt vmcnt(6)
    s_waitcnt lgkmcnt(10)
    v_mfma_f32_32x32x16_bf16 v[16:31], v[56:59], a[4:7], v[16:31]
    ds_read_b64_tr_b16 v[48:49], v131 offset:7168
    ds_read_b64_tr_b16 v[50:51], v131 offset:8192
    s_waitcnt lgkmcnt(10)
    v_mfma_f32_32x32x16_bf16 v[32:47], v[60:63], a[4:7], v[32:47]
    ds_read_b64_tr_b16 v[52:53], v132 offset:7168
    ds_read_b64_tr_b16 v[54:55], v132 offset:8192
    s_waitcnt vmcnt(5)
    s_waitcnt lgkmcnt(10)
    v_mfma_f32_32x32x16_bf16 v[16:31], v[64:67], a[8:11], v[16:31]
    ds_read_b64_tr_b16 v[56:57], v131 offset:9216
    ds_read_b64_tr_b16 v[58:59], v133 offset:10240
    s_waitcnt lgkmcnt(10)
    v_mfma_f32_32x32x16_bf16 v[32:47], v[68:71], a[8:11], v[32:47]
    ds_read_b64_tr_b16 v[60:61], v132 offset:9216
    ds_read_b64_tr_b16 v[62:63], v134 offset:10240
    s_waitcnt vmcnt(4)
    s_waitcnt lgkmcnt(10)
    v_mfma_f32_32x32x16_bf16 v[16:31], v[72:75], a[12:15], v[16:31]
    ds_read_b64_tr_b16 v[64:65], v131 offset:10752
    ds_read_b64_tr_b16 v[66:67], v131 offset:11776
    s_waitcnt lgkmcnt(10)
    v_mfma_f32_32x32x16_bf16 v[32:47], v[76:79], a[12:15], v[32:47]
    ds_read_b64_tr_b16 v[68:69], v132 offset:10752
    ds_read_b64_tr_b16 v[70:71], v132 offset:11776
    s_waitcnt vmcnt(3)
    s_waitcnt lgkmcnt(10)
    v_mfma_f32_32x32x16_bf16 v[16:31], v[48:51], a[16:19], v[16:31]
    ds_read_b64_tr_b16 v[72:73], v131 offset:12800
    ds_read_b64_tr_b16 v[74:75], v133 offset:13824
    s_waitcnt lgkmcnt(10)
    v_mfma_f32_32x32x16_bf16 v[32:47], v[52:55], a[16:19], v[32:47]
    ds_read_b64_tr_b16 v[76:77], v132 offset:12800
    ds_read_b64_tr_b16 v[78:79], v134 offset:13824
    s_waitcnt vmcnt(2)
    s_waitcnt lgkmcnt(10)
    v_mfma_f32_32x32x16_bf16 v[16:31], v[56:59], a[20:23], v[16:31]
    s_waitcnt lgkmcnt(8)
    v_mfma_f32_32x32x16_bf16 v[32:47], v[60:63], a[20:23], v[32:47]
    s_waitcnt vmcnt(1)
    s_waitcnt lgkmcnt(6)
    v_mfma_f32_32x32x16_bf16 v[16:31], v[64:67], a[24:27], v[16:31]
    s_waitcnt lgkmcnt(4)
    v_mfma_f32_32x32x16_bf16 v[32:47], v[68:71], a[24:27], v[32:47]
    s_waitcnt vmcnt(0)
    s_waitcnt lgkmcnt(2)
    v_mfma_f32_32x32x16_bf16 v[16:31], v[72:75], a[28:31], v[16:31]
    s_waitcnt lgkmcnt(0)
    v_mfma_f32_32x32x16_bf16 v[32:47], v[76:79], a[28:31], v[32:47]
    s_nop 9
    ds_write_b128 v135, v[24:27]
    ds_write_b128 v135, v[28:31] offset:1024
    ds_write_b128 v136, v[32:35]
    ds_write_b128 v136, v[36:39] offset:1024
    ds_write_b128 v137, v[40:43]
    ds_write_b128 v137, v[44:47] offset:1024
    s_waitcnt lgkmcnt(0)
    s_barrier
    ds_read_b128 v[80:83], v138 offset:0
    ds_read_b128 v[84:87], v138 offset:1024
    ds_read_b128 v[88:91], v138 offset:2048
    ds_read_b128 v[92:95], v138 offset:3072
    ds_read_b128 v[96:99], v138 offset:4096
    ds_read_b128 v[100:103], v138 offset:5120
    s_waitcnt lgkmcnt(4)
    v_pk_add_f32 v[16:17], v[16:17], v[80:81]
    v_pk_add_f32 v[18:19], v[18:19], v[82:83]
    v_pk_add_f32 v[20:21], v[20:21], v[84:85]
    v_pk_add_f32 v[22:23], v[22:23], v[86:87]
    s_waitcnt lgkmcnt(2)
    v_pk_add_f32 v[16:17], v[16:17], v[88:89]
    v_pk_add_f32 v[18:19], v[18:19], v[90:91]
    v_pk_add_f32 v[20:21], v[20:21], v[92:93]
    v_pk_add_f32 v[22:23], v[22:23], v[94:95]
    s_waitcnt lgkmcnt(0)
    v_pk_add_f32 v[16:17], v[16:17], v[96:97]
    v_pk_add_f32 v[18:19], v[18:19], v[98:99]
    v_pk_add_f32 v[20:21], v[20:21], v[100:101]
    v_pk_add_f32 v[22:23], v[22:23], v[102:103]
    v_cvt_pk_bf16_f32 v104, v16, v17
    v_cvt_pk_bf16_f32 v105, v18, v19
    v_cvt_pk_bf16_f32 v106, v20, v21
    v_cvt_pk_bf16_f32 v107, v22, v23
    buffer_store_dwordx4 v[104:107], v139, s[16:19], s58 offen
KF_FIN:
KERNEL_END:
    s_endpgm
P2_SLOW:
    s_nop 7
    s_lshl_b32 s32, s48, 12
    s_add_u32 s32, s32, 4194304
    s_add_u32 s12, s4, s32
    s_addc_u32 s13, s5, 0
    s_and_b32 s13, s13, 0xffff
    s_mov_b32 s14, 262144
    s_mov_b32 s15, 0x20000
    s_mov_b32 s46, 0x07060302
    v_accvgpr_read_b32 v112, a64
    v_accvgpr_read_b32 v113, a65
    v_accvgpr_read_b32 v114, a66
    v_accvgpr_read_b32 v115, a67
    v_accvgpr_read_b32 v116, a68
    v_accvgpr_read_b32 v117, a69
    v_accvgpr_read_b32 v118, a70
    v_accvgpr_read_b32 v119, a71
    s_mov_b32 exec_lo, 0
    s_mov_b32 exec_hi, -1
    v_mov_b32 v118, 0
    v_mov_b32 v119, 0
    s_mov_b64 exec, -1
    v_mov_b32 v8, 0xff800000
    v_mov_b32 v5, v4
    s_mov_b32 s35, 64
P2_SLOW1:
    buffer_load_dwordx4 v[96:99], v5, s[12:15], 0 offen sc1
    buffer_load_dwordx4 v[100:103], v5, s[12:15], 0 offen offset:1024 sc1
    s_waitcnt vmcnt(0)
    v_mfma_f32_32x32x16_bf16 v[16:31], v[96:99], v[112:115], 0
    v_mfma_f32_32x32x16_bf16 v[16:31], v[100:103], v[116:119], v[16:31]
    v_add_u32 v5, 4096, v5
    s_nop 10
    v_max3_f32 v8, v8, v16, v17
    v_max3_f32 v8, v8, v18, v19
    v_max3_f32 v8, v8, v20, v21
    v_max3_f32 v8, v8, v22, v23
    v_max3_f32 v8, v8, v24, v25
    v_max3_f32 v8, v8, v26, v27
    v_max3_f32 v8, v8, v28, v29
    v_max3_f32 v8, v8, v30, v31
    s_nop 7
    s_sub_u32 s35, s35, 1
    s_cmp_lg_u32 s35, 0
    s_cbranch_scc1 P2_SLOW1
    v_mov_b32 v9, v8
    s_nop 1
    v_permlane32_swap_b32 v8, v9
    v_max_f32 v8, v8, v9
    v_sub_f32 v8, 0, v8
    v_and_b32 v9, 0xffff0000, v8
    v_sub_f32 v8, v8, v9
    v_and_b32 v10, 0xffff0000, v8
    v_sub_f32 v8, v8, v10
    s_mov_b32 exec_lo, 0
    s_mov_b32 exec_hi, -1
    v_perm_b32 v118, v10, v9, s46
    v_lshrrev_b32 v119, 16, v8
    s_mov_b64 exec, -1
    v_mov_b32 v64, 0
    v_mov_b32 v65, 0
    v_mov_b32 v66, 0
    v_mov_b32 v67, 0
    v_mov_b32 v68, 0
    v_mov_b32 v69, 0
    v_mov_b32 v70, 0
    v_mov_b32 v71, 0
    v_mov_b32 v72, 0
    v_mov_b32 v73, 0
    v_mov_b32 v74, 0
    v_mov_b32 v75, 0
    v_mov_b32 v76, 0
    v_mov_b32 v77, 0
    v_mov_b32 v78, 0
    v_mov_b32 v79, 0
    v_mov_b32 v5, v4
    s_mov_b32 s35, 64
P2_SLOW2:
    buffer_load_dwordx4 v[96:99], v5, s[12:15], 0 offen offset:0 sc1
    buffer_load_dwordx4 v[100:103], v5, s[12:15], 0 offen offset:1024 sc1
    buffer_load_dwordx4 v[104:107], v5, s[12:15], 0 offen offset:2048 sc1
    buffer_load_dwordx4 v[108:111], v5, s[12:15], 0 offen offset:3072 sc1
    s_waitcnt vmcnt(0)
    v_mfma_f32_32x32x16_bf16 v[16:31], v[96:99], v[112:115], 0
    v_mfma_f32_32x32x16_bf16 v[16:31], v[100:103], v[116:119], v[16:31]
    v_add_u32 v5, 4096, v5
    s_nop 10
    v_exp_f32 v16, v16
    v_exp_f32 v17, v17
    v_exp_f32 v18, v18
    v_exp_f32 v19, v19
    v_exp_f32 v20, v20
    v_exp_f32 v21, v21
    v_exp_f32 v22, v22
    v_exp_f32 v23, v23
    v_exp_f32 v24, v24
    v_exp_f32 v25, v25
    v_exp_f32 v26, v26
    v_exp_f32 v27, v27
    v_exp_f32 v28, v28
    v_exp_f32 v29, v29
    v_exp_f32 v30, v30
    v_exp_f32 v31, v31
    v_cvt_pk_bf16_f32 v48, v16, v17
    v_cvt_pk_bf16_f32 v49, v18, v19
    v_cvt_pk_bf16_f32 v50, v20, v21
    v_cvt_pk_bf16_f32 v51, v22, v23
    v_cvt_pk_bf16_f32 v52, v24, v25
    v_cvt_pk_bf16_f32 v53, v26, v27
    v_cvt_pk_bf16_f32 v54, v28, v29
    v_cvt_pk_bf16_f32 v55, v30, v31
    v_mfma_f32_32x32x16_bf16 v[64:79], v[104:107], v[48:51], v[64:79]
    s_nop 0
    v_mfma_f32_32x32x16_bf16 v[64:79], v[108:111], v[52:55], v[64:79]
    s_nop 15
    s_sub_u32 s35, s35, 1
    s_cmp_lg_u32 s35, 0
    s_cbranch_scc1 P2_SLOW2
    s_nop 7
    s_branch P2_FIN
.section .rodata,"a"
.p2align 6
.amdhsa_kernel concat_heads__softmax_full_mha__sliding_local_dilated__prompt_kernel
  .amdhsa_next_free_vgpr 256
  .amdhsa_next_free_sgpr 102
  .amdhsa_accum_offset 144
  .amdhsa_group_segment_fixed_size 0
  .amdhsa_kernarg_size 72
  .amdhsa_user_sgpr_count 2
  .amdhsa_user_sgpr_kernarg_segment_ptr 1
  .amdhsa_system_sgpr_workgroup_id_x 1
.end_amdhsa_kernel
```
